```python
import torch

def _softmax(x, axis=-1):
    return torch.softmax(x, dim=axis)
def _gelu(x):
    return torch.nn.functional.gelu(x, approximate="tanh")
def _silu(x):
    return torch.nn.functional.silu(x)
def _sigmoid(x):
    return torch.sigmoid(x)
def _layernorm(x, axis=-1, eps=1e-5):
    m = x.mean(dim=axis, keepdim=True)
    v = x.var(dim=axis, keepdim=True, unbiased=False)
    return (x - m) / torch.sqrt(v + eps)
def _scatter_add(tgt, idx, src, axis=0):
    return tgt.clone().index_add_(axis, idx, src)
def _segment_sum(src, seg, n):
    out = torch.zeros((n,) + src.shape[1:], dtype=src.dtype)
    return out.index_add_(0, seg, src)
def _pad(x, pw):
    flat = tuple(v for pair in reversed(pw) for v in pair)
    return torch.nn.functional.pad(x, flat)

kernel_name = 'recurrent_scan__gqa_block_cached__mixer_token_mlp__decode'

def setup_inputs():

    _w = (lambda a: (lambda t: t.to(torch.bfloat16) if t.is_floating_point() else t)(torch.as_tensor(a)))
    def _A_setup():
        B, Sq, D = 8, 1, 512
        Hq, Hkv, Sk, Dh = 32, 8, 4096, 128
        assert Hq % Hkv == 0, (Hq, Hkv)
        return {
            "x": _w((lambda *s: torch.randn(*s, dtype=torch.bfloat16) * 0.4)(B, Sq, D)),
            "k_cache": _w((lambda *s: torch.randn(*s, dtype=torch.bfloat16) * 1.6)(B, Hkv, Sk, Dh)),
            "v_cache": _w((lambda *s: torch.randn(*s, dtype=torch.bfloat16) * 1.6)(B, Hkv, Sk, Dh)),
            "wq": _w((lambda *s: torch.randn(*s, dtype=torch.bfloat16) * 1.6)(D, Hq * Dh) * (D ** -0.5)),
            "wo": _w((lambda *s: torch.randn(*s, dtype=torch.bfloat16) * 1.6)(Hq * Dh, D) * ((Hq * Dh) ** -0.5)),
        }
    _A_in = _A_setup()

    def _B_setup():
        B, S, D, F = 8, 1, 512, 1792
        return {
            "x": _w((lambda *s: torch.randn(*s, dtype=torch.bfloat16) * 0.4)(B, S, D)),
            "w1": _w((lambda *s: torch.randn(*s, dtype=torch.bfloat16) * 1.6)(S, F) * (S ** -0.5)),
            "b1": _w((lambda *s: torch.randn(*s, dtype=torch.bfloat16) * 1.6)(F) * 0.02),
            "w2": _w((lambda *s: torch.randn(*s, dtype=torch.bfloat16) * 1.6)(F, S) * (F ** -0.5)),
            "b2": _w((lambda *s: torch.randn(*s, dtype=torch.bfloat16) * 1.6)(S) * 0.02),
        }
    _B_in = _B_setup()

    return {
        "A_x": _A_in["x"],
        "A_k_cache": _A_in["k_cache"],
        "A_v_cache": _A_in["v_cache"],
        "A_wq": _A_in["wq"],
        "A_wo": _A_in["wo"],
        "B_x": _B_in["x"],
        "B_w1": _B_in["w1"],
        "B_b1": _B_in["b1"],
        "B_w2": _B_in["w2"],
        "B_b2": _B_in["b2"],
    }

def reference(A_x, A_k_cache, A_v_cache, A_wq, A_wo, B_x, B_w1, B_b1, B_w2, B_b2):
    def _A_ref(x, k_cache, v_cache, wq, wo):
        B, Sq, D = x.shape
        Hq, Dh = 32, 128
        Hkv = k_cache.shape[1]
        rep = Hq // Hkv
        q = (lambda x, *d: x.permute(*d))((x @ wq).reshape(B, Sq, Hq, Dh), 0, 2, 1, 3)
        k = (lambda x, n, axis: torch.repeat_interleave(x, n, dim=axis))(k_cache, rep, axis=1)
        v = (lambda x, n, axis: torch.repeat_interleave(x, n, dim=axis))(v_cache, rep, axis=1)
        scores = torch.einsum("bhqd,bhkd->bhqk", q, k) * (Dh ** -0.5)
        p = _softmax(scores, axis=-1)
        o = torch.einsum("bhqk,bhkd->bhqd", p, v)
        return (lambda x, *d: x.permute(*d))(o, 0, 2, 1, 3).reshape(B, Sq, Hq * Dh) @ wo

    def _B_ref(x, w1, b1, w2, b2):
        B, S, D = x.shape
        h = _layernorm(x, axis=-1)
        u = torch.einsum("bsd,sf->bdf", h, w1) + b1
        u = _gelu(u)
        y = torch.einsum("bdf,fs->bds", u, w2) + b2
        return (lambda x, *d: x.permute(*d))(y, 0, 2, 1)

    x = A_x
    xn = _layernorm(x, axis=-1)
    s = _A_ref(xn, A_k_cache, A_v_cache, A_wq, A_wo)
    g = _silu(_B_ref(xn, B_w1, B_b1, B_w2, B_b2))
    return x + s * g
```

```asm
; @launch grid=(256,1,1) block=(512,1,1) lds=150080
.amdgcn_target "amdgcn-amd-amdhsa--gfx950"
.text
.globl recurrent_scan__gqa_block_cached__mixer_token_mlp__decode_kernel
.p2align 8
.type recurrent_scan__gqa_block_cached__mixer_token_mlp__decode_kernel,@function
recurrent_scan__gqa_block_cached__mixer_token_mlp__decode_kernel:
  s_load_dwordx2 s[44:45], s[0:1], 8
  v_lshrrev_b32 v2, 6, v0
  s_lshr_b32 s53, s2, 5
  v_and_b32 v1, 63, v0
  v_readfirstlane_b32 s3, v2
  s_cmp_ge_u32 s53, 8
  s_cbranch_scc1 L_end
  s_cmp_ge_u32 s3, 4
  s_cbranch_scc1 L_hstub
  s_lshl_b32 s46, 1, 26
  s_lshl_b32 s47, 1, 17
  s_and_b32 s52, s2, 7
  s_lshl3_add_u32 s52, s53, s52
  s_lshl_b32 s52, s52, 20
  s_and_b32 s53, s2, 24
  s_lshl1_add_u32 s53, s3, s53
  s_lshl_b32 s53, s53, 11
  s_or_b32 s52, s52, s53
  s_mul_i32 s60, s3, 24576
  s_add_u32 s60, s60, 51776
  s_mov_b32 m0, s60
  v_lshrrev_b32 v5, 4, v1
  v_bfe_u32 v6, v1, 2, 2
  v_and_b32 v7, 3, v1
  v_lshlrev_b32 v2, 8, v6
  v_lshl_add_u32 v2, v5, 6, v2
  v_lshl_add_u32 v2, v7, 4, v2
  s_waitcnt lgkmcnt(0)
  buffer_load_dwordx4 v2, s[44:47], s52 offen offset:0 nt lds
  buffer_load_dwordx4 v2, s[44:47], s52 offen offset:1024 nt lds
  buffer_load_dwordx4 v2, s[44:47], s52 offen offset:2048 nt lds
  buffer_load_dwordx4 v2, s[44:47], s52 offen offset:3072 nt lds
  s_add_u32 m0, s60, 4096
  s_xor_b32 s53, s52, 65536
  buffer_load_dwordx4 v2, s[44:47], s53 offen offset:0 nt lds
  buffer_load_dwordx4 v2, s[44:47], s53 offen offset:1024 nt lds
  s_branch L_go
L_hstub:
  s_lshr_b32 s4, s2, 3
  s_xor_b32 s4, s4, s3
  s_and_b32 s4, s4, 3
  s_cbranch_scc1 L_helper
  s_getpc_b64 s[4:5]
L_pc:
  v_lshlrev_b32 v2, 7, v0
  v_add_u32 v2, -32768, v2
  v_min_u32 v2, L_last-L_pc, v2
  global_load_dword v255, v2, s[4:5]
  s_branch L_helper
L_go:
  s_barrier
  s_setprio 2
  s_load_dwordx2 s[48:49], s[0:1], 16
  s_load_dwordx2 s[40:41], s[0:1], 96
  s_mov_b32 s50, 0x4000000
  s_mov_b32 s51, 0x20000
  v_lshlrev_b32 v3, 4, v1
  s_lshr_b32 s64, s2, 3
  s_cmp_eq_u32 s3, 0
  s_cselect_b32 s64, s64, 64
  s_and_b32 s65, s2, 7
  s_lshl_b32 s65, s65, 3
  v_mov_b32 v83, s65
  s_mov_b32 s54, 0x05040100
  s_mov_b32 s55, 0x07060302
  s_mov_b32 s56, 0x3db504f3
  s_mov_b32 s57, 0x3fb8aa3b
  v_lshlrev_b32 v4, 8, v7
  v_lshl_add_u32 v4, v5, 6, v4
  v_lshl_add_u32 v4, v6, 4, v4
  v_mov_b32 v84, 0
  v_add_u32 v86, s60, v3
  s_waitcnt vmcnt(4)
  buffer_load_dwordx4 v2, s[44:47], s53 offen offset:2048 nt lds
  buffer_load_dwordx4 v2, s[44:47], s53 offen offset:3072 nt lds
  s_waitcnt vmcnt(4)
  s_xor_b32 s53, s52, 131072
  s_add_u32 m0, s60, 8192
  s_nop 0
  buffer_load_dwordx4 v2, s[44:47], s53 offen offset:0 nt lds
  buffer_load_dwordx4 v2, s[44:47], s53 offen offset:1024 nt lds
  s_waitcnt lgkmcnt(0)
  s_load_dword s73, s[40:41], 0
  s_mov_b32 s76, s40
  s_mov_b32 s77, s41
  s_mov_b32 s78, 0x10000000
  s_mov_b32 s79, 0x20000
  s_waitcnt vmcnt(4)
  buffer_load_dwordx4 v2, s[44:47], s53 offen offset:2048 nt lds
  buffer_load_dwordx4 v2, s[44:47], s53 offen offset:3072 nt lds
  s_waitcnt vmcnt(10)
  s_waitcnt vmcnt(4)
  s_xor_b32 s53, s52, 196608
  s_add_u32 m0, s60, 12288
  s_nop 0
  buffer_load_dwordx4 v2, s[44:47], s53 offen offset:0 nt lds
  buffer_load_dwordx4 v2, s[44:47], s53 offen offset:1024 nt lds
  s_waitcnt lgkmcnt(0)
  s_add_u32 s73, s73, 1
  s_memrealtime s[4:5]
  s_waitcnt lgkmcnt(0)
  v_mov_b32 v6, s4
  s_sub_u32 s70, s4, 112
  v_mov_b32 v7, s73
  s_movk_i32 s65, 8192
  s_cmp_eq_u32 s64, 3
  s_cselect_b64 exec, 1, 0
  buffer_store_dwordx2 v[6:7], v83, s[76:79], s65 offen sc1
  s_mov_b64 exec, -1
  s_waitcnt vmcnt(11)
  s_waitcnt vmcnt(5)
  buffer_load_dwordx4 v2, s[44:47], s53 offen offset:2048 nt lds
  buffer_load_dwordx4 v2, s[44:47], s53 offen offset:3072 nt lds
  s_memrealtime s[4:5]
  s_waitcnt vmcnt(11)
  s_waitcnt vmcnt(5)
  s_xor_b32 s53, s52, 262144
  s_add_u32 m0, s60, 16384
  s_nop 0
  buffer_load_dwordx4 v2, s[44:47], s53 offen offset:0 nt lds
  buffer_load_dwordx4 v2, s[44:47], s53 offen offset:1024 nt lds
  s_memrealtime s[4:5]
  s_waitcnt vmcnt(11)
  s_waitcnt vmcnt(5)
  buffer_load_dwordx4 v2, s[44:47], s53 offen offset:2048 nt lds
  buffer_load_dwordx4 v2, s[44:47], s53 offen offset:3072 nt lds
  s_memrealtime s[4:5]
  s_waitcnt vmcnt(11)
  s_waitcnt vmcnt(4)
  s_xor_b32 s53, s52, 327680
  s_add_u32 m0, s60, 20480
  s_nop 0
  buffer_load_dwordx4 v2, s[44:47], s53 offen offset:0 nt lds
  buffer_load_dwordx4 v2, s[44:47], s53 offen offset:1024 nt lds
  s_memrealtime s[4:5]
  s_waitcnt vmcnt(11)
  s_waitcnt vmcnt(4)
  buffer_load_dwordx4 v2, s[44:47], s53 offen offset:2048 nt lds
  buffer_load_dwordx4 v2, s[44:47], s53 offen offset:3072 nt lds
  s_memrealtime s[4:5]
  s_load_dwordx16 s[16:31], s[40:41], 8192
  s_waitcnt vmcnt(11)
  s_waitcnt vmcnt(4)
  s_xor_b32 s53, s52, 393216
  buffer_load_dwordx4 v[96:99], v2, s[44:47], s53 offen offset:0 nt
  buffer_load_dwordx4 v[100:103], v2, s[44:47], s53 offen offset:1024 nt
  s_waitcnt vmcnt(10)
  s_waitcnt vmcnt(4)
  buffer_load_dwordx4 v[104:107], v2, s[44:47], s53 offen offset:2048 nt
  buffer_load_dwordx4 v[108:111], v2, s[44:47], s53 offen offset:3072 nt
  s_waitcnt vmcnt(10)
  s_waitcnt vmcnt(4)
  s_xor_b32 s53, s52, 458752
  buffer_load_dwordx4 v[112:115], v2, s[44:47], s53 offen offset:0 nt
  buffer_load_dwordx4 v[116:119], v2, s[44:47], s53 offen offset:1024 nt
  s_movk_i32 s62, 112
  s_call_b64 s[80:81], L_cx
  s_memrealtime s[4:5]
  s_waitcnt vmcnt(10)
  s_waitcnt lgkmcnt(0)
  s_add_u32 s68, s70, 336
  s_sub_u32 s68, s68, s4
  s_cmpk_lt_i32 s68, 65496
  s_cbranch_scc1 L_fs13
  s_waitcnt vmcnt(6)
  s_cmpk_lt_i32 s68, 65521
  s_cbranch_scc1 L_fs13
  s_waitcnt vmcnt(4)
  s_cmpk_lt_i32 s68, 15
  s_cbranch_scc1 L_fs13
  s_waitcnt vmcnt(3)
  s_cmpk_lt_i32 s68, 40
  s_cbranch_scc1 L_fs13
  s_waitcnt vmcnt(2)
L_fs13:
  buffer_load_dwordx4 v[120:123], v2, s[44:47], s53 offen offset:2048 nt
  buffer_load_dwordx4 v[124:127], v2, s[44:47], s53 offen offset:3072 nt
  s_memrealtime s[4:5]
  s_waitcnt lgkmcnt(0)
  v_mov_b32 v6, s4
  v_mov_b32 v7, s73
  s_movk_i32 s65, 8448
  s_cmp_eq_u32 s64, 8
  s_cselect_b64 exec, 1, 0
  buffer_store_dwordx2 v[6:7], v83, s[76:79], s65 offen sc1
  s_mov_b64 exec, -1
  s_waitcnt vmcnt(11)
  s_waitcnt lgkmcnt(0)
  s_add_u32 s68, s70, 364
  s_sub_u32 s68, s68, s4
  s_cmpk_lt_i32 s68, 65496
  s_cbranch_scc1 L_fs14
  s_waitcnt vmcnt(7)
  s_cmpk_lt_i32 s68, 65521
  s_cbranch_scc1 L_fs14
  s_waitcnt vmcnt(5)
  s_cmpk_lt_i32 s68, 15
  s_cbranch_scc1 L_fs14
  s_waitcnt vmcnt(4)
  s_cmpk_lt_i32 s68, 40
  s_cbranch_scc1 L_fs14
  s_waitcnt vmcnt(3)
L_fs14:
  s_xor_b32 s53, s52, 524288
  buffer_load_dwordx4 v[128:131], v2, s[44:47], s53 offen offset:0 nt
  buffer_load_dwordx4 v[132:135], v2, s[44:47], s53 offen offset:1024 nt
  s_memrealtime s[4:5]
  s_waitcnt vmcnt(11)
  s_waitcnt lgkmcnt(0)
  s_add_u32 s68, s70, 392
  s_sub_u32 s68, s68, s4
  s_cmpk_lt_i32 s68, 65496
  s_cbranch_scc1 L_fs15
  s_waitcnt vmcnt(7)
  s_cmpk_lt_i32 s68, 65521
  s_cbranch_scc1 L_fs15
  s_waitcnt vmcnt(5)
  s_cmpk_lt_i32 s68, 15
  s_cbranch_scc1 L_fs15
  s_waitcnt vmcnt(4)
  s_cmpk_lt_i32 s68, 40
  s_cbranch_scc1 L_fs15
  s_waitcnt vmcnt(3)
L_fs15:
  buffer_load_dwordx4 v[136:139], v2, s[44:47], s53 offen offset:2048 nt
  buffer_load_dwordx4 v[140:143], v2, s[44:47], s53 offen offset:3072 nt
  s_memrealtime s[4:5]
  s_waitcnt vmcnt(11)
  s_waitcnt lgkmcnt(0)
  s_add_u32 s68, s70, 420
  s_sub_u32 s68, s68, s4
  s_cmpk_lt_i32 s68, 65496
  s_cbranch_scc1 L_fs16
  s_waitcnt vmcnt(7)
  s_cmpk_lt_i32 s68, 65521
  s_cbranch_scc1 L_fs16
  s_waitcnt vmcnt(5)
  s_cmpk_lt_i32 s68, 15
  s_cbranch_scc1 L_fs16
  s_waitcnt vmcnt(3)
  s_cmpk_lt_i32 s68, 40
  s_cbranch_scc1 L_fs16
  s_waitcnt vmcnt(2)
L_fs16:
  s_xor_b32 s53, s52, 589824
  buffer_load_dwordx4 v[144:147], v2, s[44:47], s53 offen offset:0 nt
  buffer_load_dwordx4 v[148:151], v2, s[44:47], s53 offen offset:1024 nt
  s_memrealtime s[4:5]
  s_waitcnt vmcnt(11)
  s_waitcnt lgkmcnt(0)
  s_add_u32 s68, s70, 448
  s_sub_u32 s68, s68, s4
  s_cmpk_lt_i32 s68, 65496
  s_cbranch_scc1 L_fs17
  s_waitcnt vmcnt(7)
  s_cmpk_lt_i32 s68, 65521
  s_cbranch_scc1 L_fs17
  s_waitcnt vmcnt(4)
  s_cmpk_lt_i32 s68, 15
  s_cbranch_scc1 L_fs17
  s_waitcnt vmcnt(3)
  s_cmpk_lt_i32 s68, 40
  s_cbranch_scc1 L_fs17
  s_waitcnt vmcnt(2)
L_fs17:
  buffer_load_dwordx4 v[152:155], v2, s[44:47], s53 offen offset:2048 nt
  buffer_load_dwordx4 v[156:159], v2, s[44:47], s53 offen offset:3072 nt
  s_memrealtime s[4:5]
  s_waitcnt vmcnt(11)
  s_waitcnt lgkmcnt(0)
  s_add_u32 s68, s70, 476
  s_sub_u32 s68, s68, s4
  s_cmpk_lt_i32 s68, 65496
  s_cbranch_scc1 L_fs18
  s_waitcnt vmcnt(6)
  s_cmpk_lt_i32 s68, 65521
  s_cbranch_scc1 L_fs18
  s_waitcnt vmcnt(4)
  s_cmpk_lt_i32 s68, 15
  s_cbranch_scc1 L_fs18
  s_waitcnt vmcnt(3)
  s_cmpk_lt_i32 s68, 40
  s_cbranch_scc1 L_fs18
  s_waitcnt vmcnt(2)
L_fs18:
  s_xor_b32 s53, s52, 655360
  buffer_load_dwordx4 v[160:163], v2, s[44:47], s53 offen offset:0 nt
  buffer_load_dwordx4 v[164:167], v2, s[44:47], s53 offen offset:1024 nt
  s_memrealtime s[4:5]
  s_load_dwordx16 s[16:31], s[40:41], 8448
  s_waitcnt vmcnt(11)
  s_cmpk_lt_i32 s68, 65496
  s_cbranch_scc1 L_fs19
  s_waitcnt vmcnt(6)
  s_cmpk_lt_i32 s68, 65521
  s_cbranch_scc1 L_fs19
  s_waitcnt vmcnt(4)
  s_cmpk_lt_i32 s68, 15
  s_cbranch_scc1 L_fs19
  s_waitcnt vmcnt(3)
  s_cmpk_lt_i32 s68, 40
  s_cbranch_scc1 L_fs19
  s_waitcnt vmcnt(2)
L_fs19:
  buffer_load_dwordx4 v[168:171], v2, s[44:47], s53 offen offset:2048 nt
  buffer_load_dwordx4 v[172:175], v2, s[44:47], s53 offen offset:3072 nt
  s_waitcnt vmcnt(10)
  s_cmpk_lt_i32 s68, 65496
  s_cbranch_scc1 L_fs20
  s_waitcnt vmcnt(6)
  s_cmpk_lt_i32 s68, 65521
  s_cbranch_scc1 L_fs20
  s_waitcnt vmcnt(4)
  s_cmpk_lt_i32 s68, 15
  s_cbranch_scc1 L_fs20
  s_waitcnt vmcnt(3)
  s_cmpk_lt_i32 s68, 40
  s_cbranch_scc1 L_fs20
  s_waitcnt vmcnt(2)
L_fs20:
  s_xor_b32 s53, s52, 720896
  buffer_load_dwordx4 v[176:179], v2, s[44:47], s53 offen offset:0 nt
  buffer_load_dwordx4 v[180:183], v2, s[44:47], s53 offen offset:1024 nt
  s_waitcnt vmcnt(10)
  s_cmpk_lt_i32 s68, 65496
  s_cbranch_scc1 L_fs21
  s_waitcnt vmcnt(6)
  s_cmpk_lt_i32 s68, 65521
  s_cbranch_scc1 L_fs21
  s_waitcnt vmcnt(4)
  s_cmpk_lt_i32 s68, 15
  s_cbranch_scc1 L_fs21
  s_waitcnt vmcnt(3)
  s_cmpk_lt_i32 s68, 40
  s_cbranch_scc1 L_fs21
  s_waitcnt vmcnt(2)
L_fs21:
  buffer_load_dwordx4 v[184:187], v2, s[44:47], s53 offen offset:2048 nt
  buffer_load_dwordx4 v[188:191], v2, s[44:47], s53 offen offset:3072 nt
  s_movk_i32 s62, 364
  s_call_b64 s[80:81], L_cx
  s_memrealtime s[4:5]
  s_waitcnt vmcnt(10)
  s_waitcnt lgkmcnt(0)
  s_add_u32 s68, s70, 588
  s_sub_u32 s68, s68, s4
  s_cmpk_lt_i32 s68, 65496
  s_cbranch_scc1 L_fs22
  s_waitcnt vmcnt(6)
  s_cmpk_lt_i32 s68, 65521
  s_cbranch_scc1 L_fs22
  s_waitcnt vmcnt(4)
  s_cmpk_lt_i32 s68, 15
  s_cbranch_scc1 L_fs22
  s_waitcnt vmcnt(3)
  s_cmpk_lt_i32 s68, 40
  s_cbranch_scc1 L_fs22
  s_waitcnt vmcnt(2)
L_fs22:
  s_xor_b32 s53, s52, 786432
  buffer_load_dwordx4 v[192:195], v2, s[44:47], s53 offen offset:0 nt
  buffer_load_dwordx4 v[196:199], v2, s[44:47], s53 offen offset:1024 nt
  s_memrealtime s[4:5]
  s_waitcnt lgkmcnt(0)
  v_mov_b32 v6, s4
  v_mov_b32 v7, s73
  s_movk_i32 s65, 8704
  s_cmp_eq_u32 s64, 13
  s_cselect_b64 exec, 1, 0
  buffer_store_dwordx2 v[6:7], v83, s[76:79], s65 offen sc1
  s_mov_b64 exec, -1
  s_waitcnt vmcnt(11)
  s_waitcnt lgkmcnt(0)
  s_add_u32 s68, s70, 616
  s_sub_u32 s68, s68, s4
  s_cmpk_lt_i32 s68, 65496
  s_cbranch_scc1 L_fs23
  s_waitcnt vmcnt(7)
  s_cmpk_lt_i32 s68, 65521
  s_cbranch_scc1 L_fs23
  s_waitcnt vmcnt(5)
  s_cmpk_lt_i32 s68, 15
  s_cbranch_scc1 L_fs23
  s_waitcnt vmcnt(4)
  s_cmpk_lt_i32 s68, 40
  s_cbranch_scc1 L_fs23
  s_waitcnt vmcnt(3)
L_fs23:
  buffer_load_dwordx4 v[200:203], v2, s[44:47], s53 offen offset:2048 nt
  buffer_load_dwordx4 v[204:207], v2, s[44:47], s53 offen offset:3072 nt
  s_memrealtime s[4:5]
  s_waitcnt vmcnt(11)
  s_waitcnt lgkmcnt(0)
  s_add_u32 s68, s70, 644
  s_sub_u32 s68, s68, s4
  s_cmpk_lt_i32 s68, 65496
  s_cbranch_scc1 L_fs24
  s_waitcnt vmcnt(7)
  s_cmpk_lt_i32 s68, 65521
  s_cbranch_scc1 L_fs24
  s_waitcnt vmcnt(5)
  s_cmpk_lt_i32 s68, 15
  s_cbranch_scc1 L_fs24
  s_waitcnt vmcnt(4)
  s_cmpk_lt_i32 s68, 40
  s_cbranch_scc1 L_fs24
  s_waitcnt vmcnt(3)
L_fs24:
  s_xor_b32 s53, s52, 851968
  buffer_load_dwordx4 v[208:211], v2, s[44:47], s53 offen offset:0 nt
  buffer_load_dwordx4 v[212:215], v2, s[44:47], s53 offen offset:1024 nt
  s_memrealtime s[4:5]
  s_waitcnt vmcnt(11)
  s_waitcnt lgkmcnt(0)
  s_add_u32 s68, s70, 672
  s_sub_u32 s68, s68, s4
  s_cmpk_lt_i32 s68, 65496
  s_cbranch_scc1 L_fs25
  s_waitcnt vmcnt(7)
  s_cmpk_lt_i32 s68, 65521
  s_cbranch_scc1 L_fs25
  s_waitcnt vmcnt(5)
  s_cmpk_lt_i32 s68, 15
  s_cbranch_scc1 L_fs25
  s_waitcnt vmcnt(3)
  s_cmpk_lt_i32 s68, 40
  s_cbranch_scc1 L_fs25
  s_waitcnt vmcnt(2)
L_fs25:
  buffer_load_dwordx4 v[216:219], v2, s[44:47], s53 offen offset:2048 nt
  buffer_load_dwordx4 v[220:223], v2, s[44:47], s53 offen offset:3072 nt
  s_memrealtime s[4:5]
  s_waitcnt vmcnt(11)
  s_waitcnt lgkmcnt(0)
  s_add_u32 s68, s70, 700
  s_sub_u32 s68, s68, s4
  s_cmpk_lt_i32 s68, 65496
  s_cbranch_scc1 L_fs26
  s_waitcnt vmcnt(7)
  s_cmpk_lt_i32 s68, 65521
  s_cbranch_scc1 L_fs26
  s_waitcnt vmcnt(4)
  s_cmpk_lt_i32 s68, 15
  s_cbranch_scc1 L_fs26
  s_waitcnt vmcnt(3)
  s_cmpk_lt_i32 s68, 40
  s_cbranch_scc1 L_fs26
  s_waitcnt vmcnt(2)
L_fs26:
  s_xor_b32 s53, s52, 917504
  buffer_load_dwordx4 v[224:227], v2, s[44:47], s53 offen offset:0 nt
  buffer_load_dwordx4 v[228:231], v2, s[44:47], s53 offen offset:1024 nt
  s_memrealtime s[4:5]
  s_waitcnt vmcnt(11)
  s_waitcnt lgkmcnt(0)
  s_add_u32 s68, s70, 728
  s_sub_u32 s68, s68, s4
  s_cmpk_lt_i32 s68, 65496
  s_cbranch_scc1 L_fs27
  s_waitcnt vmcnt(6)
  s_cmpk_lt_i32 s68, 65521
  s_cbranch_scc1 L_fs27
  s_waitcnt vmcnt(4)
  s_cmpk_lt_i32 s68, 15
  s_cbranch_scc1 L_fs27
  s_waitcnt vmcnt(3)
  s_cmpk_lt_i32 s68, 40
  s_cbranch_scc1 L_fs27
  s_waitcnt vmcnt(2)
L_fs27:
  buffer_load_dwordx4 v[232:235], v2, s[44:47], s53 offen offset:2048 nt
  buffer_load_dwordx4 v[236:239], v2, s[44:47], s53 offen offset:3072 nt
  s_memrealtime s[4:5]
  s_load_dwordx16 s[16:31], s[40:41], 8704
  s_waitcnt vmcnt(11)
  s_cmpk_lt_i32 s68, 65496
  s_cbranch_scc1 L_fs28
  s_waitcnt vmcnt(6)
  s_cmpk_lt_i32 s68, 65521
  s_cbranch_scc1 L_fs28
  s_waitcnt vmcnt(4)
  s_cmpk_lt_i32 s68, 15
  s_cbranch_scc1 L_fs28
  s_waitcnt vmcnt(3)
  s_cmpk_lt_i32 s68, 40
  s_cbranch_scc1 L_fs28
  s_waitcnt vmcnt(2)
L_fs28:
  s_xor_b32 s53, s52, 983040
  buffer_load_dwordx4 v[240:243], v2, s[44:47], s53 offen offset:0 nt
  buffer_load_dwordx4 v[244:247], v2, s[44:47], s53 offen offset:1024 nt
  s_waitcnt vmcnt(10)
  s_cmpk_lt_i32 s68, 65496
  s_cbranch_scc1 L_fs29
  s_waitcnt vmcnt(6)
  s_cmpk_lt_i32 s68, 65521
  s_cbranch_scc1 L_fs29
  s_waitcnt vmcnt(4)
  s_cmpk_lt_i32 s68, 15
  s_cbranch_scc1 L_fs29
  s_waitcnt vmcnt(3)
  s_cmpk_lt_i32 s68, 40
  s_cbranch_scc1 L_fs29
  s_waitcnt vmcnt(2)
L_fs29:
  buffer_load_dwordx4 v[248:251], v2, s[44:47], s53 offen offset:2048 nt
  buffer_load_dwordx4 v[252:255], v2, s[44:47], s53 offen offset:3072 nt
  s_mov_b32 s58, 3200000
L_sq:
  ds_read_b32 v85, v84 offset:4
  s_waitcnt lgkmcnt(0)
  v_readfirstlane_b32 s59, v85
  s_sub_u32 s58, s58, 1
  s_cbranch_scc1 L_sq_done
  s_cmp_ge_u32 s59, 4
  s_cbranch_scc1 L_sq_done
  s_sleep 1
  s_branch L_sq
L_sq_done:
  ds_read_b128 v[8:11], v4 offset:64
  s_waitcnt lgkmcnt(0)
  v_mfma_f32_16x16x32_bf16 v[28:31], v[96:99], v[8:11], 0
  v_mfma_f32_16x16x32_bf16 v[32:35], v[100:103], v[8:11], 0
  v_mfma_f32_16x16x32_bf16 v[36:39], v[104:107], v[8:11], 0
  v_mfma_f32_16x16x32_bf16 v[40:43], v[108:111], v[8:11], 0
  s_nop 4
  v_mov_b32_dpp v44, v28 quad_perm:[0,1,2,3] row_mask:0xf bank_mask:0x1
  v_mov_b32_dpp v45, v29 row_ror:12 row_mask:0xf bank_mask:0x1
  v_mov_b32_dpp v46, v30 row_ror:8 row_mask:0xf bank_mask:0x1
  v_mov_b32_dpp v47, v31 row_ror:4 row_mask:0xf bank_mask:0x1
  v_mov_b32_dpp v44, v32 row_ror:4 row_mask:0xf bank_mask:0x2
  v_mov_b32_dpp v45, v33 quad_perm:[0,1,2,3] row_mask:0xf bank_mask:0x2
  v_mov_b32_dpp v46, v34 row_ror:12 row_mask:0xf bank_mask:0x2
  v_mov_b32_dpp v47, v35 row_ror:8 row_mask:0xf bank_mask:0x2
  v_mov_b32_dpp v44, v36 row_ror:8 row_mask:0xf bank_mask:0x4
  v_mov_b32_dpp v45, v37 row_ror:4 row_mask:0xf bank_mask:0x4
  v_mov_b32_dpp v46, v38 quad_perm:[0,1,2,3] row_mask:0xf bank_mask:0x4
  v_mov_b32_dpp v47, v39 row_ror:12 row_mask:0xf bank_mask:0x4
  v_mov_b32_dpp v44, v40 row_ror:12 row_mask:0xf bank_mask:0x8
  v_mov_b32_dpp v45, v41 row_ror:8 row_mask:0xf bank_mask:0x8
  v_mov_b32_dpp v46, v42 row_ror:4 row_mask:0xf bank_mask:0x8
  v_mov_b32_dpp v47, v43 quad_perm:[0,1,2,3] row_mask:0xf bank_mask:0x8
  v_add_f32 v44, v44, v45
  v_add_f32 v46, v46, v47
  v_add_f32 v18, v44, v46
  v_cvt_pk_bf16_f32 v18, v18, v18
  v_lshlrev_b32 v18, 16, v18
  v_mul_f32 v18, s56, v18
  v_cvt_pk_bf16_f32 v18, v18, v18
  v_lshlrev_b32 v18, 16, v18
  s_waitcnt vmcnt(10)
  s_cmpk_lt_i32 s68, 65496
  s_cbranch_scc1 L_fs30
  s_waitcnt vmcnt(6)
  s_cmpk_lt_i32 s68, 65521
  s_cbranch_scc1 L_fs30
  s_waitcnt vmcnt(4)
  s_cmpk_lt_i32 s68, 15
  s_cbranch_scc1 L_fs30
  s_waitcnt vmcnt(3)
  s_cmpk_lt_i32 s68, 40
  s_cbranch_scc1 L_fs30
  s_waitcnt vmcnt(2)
L_fs30:
  s_xor_b32 s53, s52, 0
  buffer_load_dwordx4 v[96:99], v3, s[48:51], s53 offen offset:0 nt
  buffer_load_dwordx4 v[100:103], v3, s[48:51], s53 offen offset:1024 nt
  s_movk_i32 s62, 616
  s_call_b64 s[80:81], L_cx
  s_memrealtime s[4:5]
  v_mfma_f32_16x16x32_bf16 v[28:31], v[112:115], v[8:11], 0
  v_mfma_f32_16x16x32_bf16 v[32:35], v[116:119], v[8:11], 0
  v_mfma_f32_16x16x32_bf16 v[36:39], v[120:123], v[8:11], 0
  v_mfma_f32_16x16x32_bf16 v[40:43], v[124:127], v[8:11], 0
  s_nop 4
  v_mov_b32_dpp v44, v28 quad_perm:[0,1,2,3] row_mask:0xf bank_mask:0x1
  v_mov_b32_dpp v45, v29 row_ror:12 row_mask:0xf bank_mask:0x1
  v_mov_b32_dpp v46, v30 row_ror:8 row_mask:0xf bank_mask:0x1
  v_mov_b32_dpp v47, v31 row_ror:4 row_mask:0xf bank_mask:0x1
  v_mov_b32_dpp v44, v32 row_ror:4 row_mask:0xf bank_mask:0x2
  v_mov_b32_dpp v45, v33 quad_perm:[0,1,2,3] row_mask:0xf bank_mask:0x2
  v_mov_b32_dpp v46, v34 row_ror:12 row_mask:0xf bank_mask:0x2
  v_mov_b32_dpp v47, v35 row_ror:8 row_mask:0xf bank_mask:0x2
  v_mov_b32_dpp v44, v36 row_ror:8 row_mask:0xf bank_mask:0x4
  v_mov_b32_dpp v45, v37 row_ror:4 row_mask:0xf bank_mask:0x4
  v_mov_b32_dpp v46, v38 quad_perm:[0,1,2,3] row_mask:0xf bank_mask:0x4
  v_mov_b32_dpp v47, v39 row_ror:12 row_mask:0xf bank_mask:0x4
  v_mov_b32_dpp v44, v40 row_ror:12 row_mask:0xf bank_mask:0x8
  v_mov_b32_dpp v45, v41 row_ror:8 row_mask:0xf bank_mask:0x8
  v_mov_b32_dpp v46, v42 row_ror:4 row_mask:0xf bank_mask:0x8
  v_mov_b32_dpp v47, v43 quad_perm:[0,1,2,3] row_mask:0xf bank_mask:0x8
  v_add_f32 v44, v44, v45
  v_add_f32 v46, v46, v47
  v_add_f32 v19, v44, v46
  v_cvt_pk_bf16_f32 v19, v19, v19
  v_lshlrev_b32 v19, 16, v19
  v_mul_f32 v19, s56, v19
  v_cvt_pk_bf16_f32 v19, v19, v19
  v_lshlrev_b32 v19, 16, v19
  s_waitcnt vmcnt(10)
  s_waitcnt lgkmcnt(0)
  s_add_u32 s68, s70, 840
  s_sub_u32 s68, s68, s4
  s_cmpk_lt_i32 s68, 65496
  s_cbranch_scc1 L_fs31
  s_waitcnt vmcnt(6)
  s_cmpk_lt_i32 s68, 65521
  s_cbranch_scc1 L_fs31
  s_waitcnt vmcnt(4)
  s_cmpk_lt_i32 s68, 15
  s_cbranch_scc1 L_fs31
  s_waitcnt vmcnt(3)
  s_cmpk_lt_i32 s68, 40
  s_cbranch_scc1 L_fs31
  s_waitcnt vmcnt(2)
L_fs31:
  buffer_load_dwordx4 v[104:107], v3, s[48:51], s53 offen offset:2048 nt
  buffer_load_dwordx4 v[108:111], v3, s[48:51], s53 offen offset:3072 nt
  s_memrealtime s[4:5]
  s_waitcnt lgkmcnt(0)
  v_mov_b32 v6, s4
  v_mov_b32 v7, s73
  s_movk_i32 s65, 8960
  s_cmp_eq_u32 s64, 18
  s_cselect_b64 exec, 1, 0
  buffer_store_dwordx2 v[6:7], v83, s[76:79], s65 offen sc1
  s_mov_b64 exec, -1
  v_mfma_f32_16x16x32_bf16 v[28:31], v[128:131], v[8:11], 0
  v_mfma_f32_16x16x32_bf16 v[32:35], v[132:135], v[8:11], 0
  v_mfma_f32_16x16x32_bf16 v[36:39], v[136:139], v[8:11], 0
  v_mfma_f32_16x16x32_bf16 v[40:43], v[140:143], v[8:11], 0
  s_nop 4
  v_mov_b32_dpp v44, v28 quad_perm:[0,1,2,3] row_mask:0xf bank_mask:0x1
  v_mov_b32_dpp v45, v29 row_ror:12 row_mask:0xf bank_mask:0x1
  v_mov_b32_dpp v46, v30 row_ror:8 row_mask:0xf bank_mask:0x1
  v_mov_b32_dpp v47, v31 row_ror:4 row_mask:0xf bank_mask:0x1
  v_mov_b32_dpp v44, v32 row_ror:4 row_mask:0xf bank_mask:0x2
  v_mov_b32_dpp v45, v33 quad_perm:[0,1,2,3] row_mask:0xf bank_mask:0x2
  v_mov_b32_dpp v46, v34 row_ror:12 row_mask:0xf bank_mask:0x2
  v_mov_b32_dpp v47, v35 row_ror:8 row_mask:0xf bank_mask:0x2
  v_mov_b32_dpp v44, v36 row_ror:8 row_mask:0xf bank_mask:0x4
  v_mov_b32_dpp v45, v37 row_ror:4 row_mask:0xf bank_mask:0x4
  v_mov_b32_dpp v46, v38 quad_perm:[0,1,2,3] row_mask:0xf bank_mask:0x4
  v_mov_b32_dpp v47, v39 row_ror:12 row_mask:0xf bank_mask:0x4
  v_mov_b32_dpp v44, v40 row_ror:12 row_mask:0xf bank_mask:0x8
  v_mov_b32_dpp v45, v41 row_ror:8 row_mask:0xf bank_mask:0x8
  v_mov_b32_dpp v46, v42 row_ror:4 row_mask:0xf bank_mask:0x8
  v_mov_b32_dpp v47, v43 quad_perm:[0,1,2,3] row_mask:0xf bank_mask:0x8
  v_add_f32 v44, v44, v45
  v_add_f32 v46, v46, v47
  v_add_f32 v20, v44, v46
  v_cvt_pk_bf16_f32 v20, v20, v20
  v_lshlrev_b32 v20, 16, v20
  v_mul_f32 v20, s56, v20
  v_cvt_pk_bf16_f32 v20, v20, v20
  v_lshlrev_b32 v20, 16, v20
  s_waitcnt vmcnt(11)
  s_waitcnt lgkmcnt(0)
  s_add_u32 s68, s70, 868
  s_sub_u32 s68, s68, s4
  s_cmpk_lt_i32 s68, 65496
  s_cbranch_scc1 L_fs32
  s_waitcnt vmcnt(7)
  s_cmpk_lt_i32 s68, 65521
  s_cbranch_scc1 L_fs32
  s_waitcnt vmcnt(5)
  s_cmpk_lt_i32 s68, 15
  s_cbranch_scc1 L_fs32
  s_waitcnt vmcnt(4)
  s_cmpk_lt_i32 s68, 40
  s_cbranch_scc1 L_fs32
  s_waitcnt vmcnt(3)
L_fs32:
  s_xor_b32 s53, s52, 65536
  buffer_load_dwordx4 v[112:115], v3, s[48:51], s53 offen offset:0 nt
  buffer_load_dwordx4 v[116:119], v3, s[48:51], s53 offen offset:1024 nt
  s_memrealtime s[4:5]
  v_mfma_f32_16x16x32_bf16 v[28:31], v[144:147], v[8:11], 0
  v_mfma_f32_16x16x32_bf16 v[32:35], v[148:151], v[8:11], 0
  v_mfma_f32_16x16x32_bf16 v[36:39], v[152:155], v[8:11], 0
  v_mfma_f32_16x16x32_bf16 v[40:43], v[156:159], v[8:11], 0
  s_nop 4
  v_mov_b32_dpp v44, v28 quad_perm:[0,1,2,3] row_mask:0xf bank_mask:0x1
  v_mov_b32_dpp v45, v29 row_ror:12 row_mask:0xf bank_mask:0x1
  v_mov_b32_dpp v46, v30 row_ror:8 row_mask:0xf bank_mask:0x1
  v_mov_b32_dpp v47, v31 row_ror:4 row_mask:0xf bank_mask:0x1
  v_mov_b32_dpp v44, v32 row_ror:4 row_mask:0xf bank_mask:0x2
  v_mov_b32_dpp v45, v33 quad_perm:[0,1,2,3] row_mask:0xf bank_mask:0x2
  v_mov_b32_dpp v46, v34 row_ror:12 row_mask:0xf bank_mask:0x2
  v_mov_b32_dpp v47, v35 row_ror:8 row_mask:0xf bank_mask:0x2
  v_mov_b32_dpp v44, v36 row_ror:8 row_mask:0xf bank_mask:0x4
  v_mov_b32_dpp v45, v37 row_ror:4 row_mask:0xf bank_mask:0x4
  v_mov_b32_dpp v46, v38 quad_perm:[0,1,2,3] row_mask:0xf bank_mask:0x4
  v_mov_b32_dpp v47, v39 row_ror:12 row_mask:0xf bank_mask:0x4
  v_mov_b32_dpp v44, v40 row_ror:12 row_mask:0xf bank_mask:0x8
  v_mov_b32_dpp v45, v41 row_ror:8 row_mask:0xf bank_mask:0x8
  v_mov_b32_dpp v46, v42 row_ror:4 row_mask:0xf bank_mask:0x8
  v_mov_b32_dpp v47, v43 quad_perm:[0,1,2,3] row_mask:0xf bank_mask:0x8
  v_add_f32 v44, v44, v45
  v_add_f32 v46, v46, v47
  v_add_f32 v21, v44, v46
  v_cvt_pk_bf16_f32 v21, v21, v21
  v_lshlrev_b32 v21, 16, v21
  v_mul_f32 v21, s56, v21
  v_cvt_pk_bf16_f32 v21, v21, v21
  v_lshlrev_b32 v21, 16, v21
  s_waitcnt vmcnt(11)
  s_waitcnt lgkmcnt(0)
  s_add_u32 s68, s70, 896
  s_sub_u32 s68, s68, s4
  s_cmpk_lt_i32 s68, 65496
  s_cbranch_scc1 L_fs33
  s_waitcnt vmcnt(7)
  s_cmpk_lt_i32 s68, 65521
  s_cbranch_scc1 L_fs33
  s_waitcnt vmcnt(5)
  s_cmpk_lt_i32 s68, 15
  s_cbranch_scc1 L_fs33
  s_waitcnt vmcnt(4)
  s_cmpk_lt_i32 s68, 40
  s_cbranch_scc1 L_fs33
  s_waitcnt vmcnt(3)
L_fs33:
  buffer_load_dwordx4 v[120:123], v3, s[48:51], s53 offen offset:2048 nt
  buffer_load_dwordx4 v[124:127], v3, s[48:51], s53 offen offset:3072 nt
  s_memrealtime s[4:5]
  v_mfma_f32_16x16x32_bf16 v[28:31], v[160:163], v[8:11], 0
  v_mfma_f32_16x16x32_bf16 v[32:35], v[164:167], v[8:11], 0
  v_mfma_f32_16x16x32_bf16 v[36:39], v[168:171], v[8:11], 0
  v_mfma_f32_16x16x32_bf16 v[40:43], v[172:175], v[8:11], 0
  s_nop 4
  v_mov_b32_dpp v44, v28 quad_perm:[0,1,2,3] row_mask:0xf bank_mask:0x1
  v_mov_b32_dpp v45, v29 row_ror:12 row_mask:0xf bank_mask:0x1
  v_mov_b32_dpp v46, v30 row_ror:8 row_mask:0xf bank_mask:0x1
  v_mov_b32_dpp v47, v31 row_ror:4 row_mask:0xf bank_mask:0x1
  v_mov_b32_dpp v44, v32 row_ror:4 row_mask:0xf bank_mask:0x2
  v_mov_b32_dpp v45, v33 quad_perm:[0,1,2,3] row_mask:0xf bank_mask:0x2
  v_mov_b32_dpp v46, v34 row_ror:12 row_mask:0xf bank_mask:0x2
  v_mov_b32_dpp v47, v35 row_ror:8 row_mask:0xf bank_mask:0x2
  v_mov_b32_dpp v44, v36 row_ror:8 row_mask:0xf bank_mask:0x4
  v_mov_b32_dpp v45, v37 row_ror:4 row_mask:0xf bank_mask:0x4
  v_mov_b32_dpp v46, v38 quad_perm:[0,1,2,3] row_mask:0xf bank_mask:0x4
  v_mov_b32_dpp v47, v39 row_ror:12 row_mask:0xf bank_mask:0x4
  v_mov_b32_dpp v44, v40 row_ror:12 row_mask:0xf bank_mask:0x8
  v_mov_b32_dpp v45, v41 row_ror:8 row_mask:0xf bank_mask:0x8
  v_mov_b32_dpp v46, v42 row_ror:4 row_mask:0xf bank_mask:0x8
  v_mov_b32_dpp v47, v43 quad_perm:[0,1,2,3] row_mask:0xf bank_mask:0x8
  v_add_f32 v44, v44, v45
  v_add_f32 v46, v46, v47
  v_add_f32 v22, v44, v46
  v_cvt_pk_bf16_f32 v22, v22, v22
  v_lshlrev_b32 v22, 16, v22
  v_mul_f32 v22, s56, v22
  v_cvt_pk_bf16_f32 v22, v22, v22
  v_lshlrev_b32 v22, 16, v22
  s_waitcnt vmcnt(11)
  s_waitcnt lgkmcnt(0)
  s_add_u32 s68, s70, 924
  s_sub_u32 s68, s68, s4
  s_cmpk_lt_i32 s68, 65496
  s_cbranch_scc1 L_fs34
  s_waitcnt vmcnt(7)
  s_cmpk_lt_i32 s68, 65521
  s_cbranch_scc1 L_fs34
  s_waitcnt vmcnt(5)
  s_cmpk_lt_i32 s68, 15
  s_cbranch_scc1 L_fs34
  s_waitcnt vmcnt(3)
  s_cmpk_lt_i32 s68, 40
  s_cbranch_scc1 L_fs34
  s_waitcnt vmcnt(2)
L_fs34:
  s_xor_b32 s53, s52, 131072
  buffer_load_dwordx4 v[128:131], v3, s[48:51], s53 offen offset:0 nt
  buffer_load_dwordx4 v[132:135], v3, s[48:51], s53 offen offset:1024 nt
  s_memrealtime s[4:5]
  v_mfma_f32_16x16x32_bf16 v[28:31], v[176:179], v[8:11], 0
  v_mfma_f32_16x16x32_bf16 v[32:35], v[180:183], v[8:11], 0
  v_mfma_f32_16x16x32_bf16 v[36:39], v[184:187], v[8:11], 0
  v_mfma_f32_16x16x32_bf16 v[40:43], v[188:191], v[8:11], 0
  s_nop 4
  v_mov_b32_dpp v44, v28 quad_perm:[0,1,2,3] row_mask:0xf bank_mask:0x1
  v_mov_b32_dpp v45, v29 row_ror:12 row_mask:0xf bank_mask:0x1
  v_mov_b32_dpp v46, v30 row_ror:8 row_mask:0xf bank_mask:0x1
  v_mov_b32_dpp v47, v31 row_ror:4 row_mask:0xf bank_mask:0x1
  v_mov_b32_dpp v44, v32 row_ror:4 row_mask:0xf bank_mask:0x2
  v_mov_b32_dpp v45, v33 quad_perm:[0,1,2,3] row_mask:0xf bank_mask:0x2
  v_mov_b32_dpp v46, v34 row_ror:12 row_mask:0xf bank_mask:0x2
  v_mov_b32_dpp v47, v35 row_ror:8 row_mask:0xf bank_mask:0x2
  v_mov_b32_dpp v44, v36 row_ror:8 row_mask:0xf bank_mask:0x4
  v_mov_b32_dpp v45, v37 row_ror:4 row_mask:0xf bank_mask:0x4
  v_mov_b32_dpp v46, v38 quad_perm:[0,1,2,3] row_mask:0xf bank_mask:0x4
  v_mov_b32_dpp v47, v39 row_ror:12 row_mask:0xf bank_mask:0x4
  v_mov_b32_dpp v44, v40 row_ror:12 row_mask:0xf bank_mask:0x8
  v_mov_b32_dpp v45, v41 row_ror:8 row_mask:0xf bank_mask:0x8
  v_mov_b32_dpp v46, v42 row_ror:4 row_mask:0xf bank_mask:0x8
  v_mov_b32_dpp v47, v43 quad_perm:[0,1,2,3] row_mask:0xf bank_mask:0x8
  v_add_f32 v44, v44, v45
  v_add_f32 v46, v46, v47
  v_add_f32 v23, v44, v46
  v_cvt_pk_bf16_f32 v23, v23, v23
  v_lshlrev_b32 v23, 16, v23
  v_mul_f32 v23, s56, v23
  v_cvt_pk_bf16_f32 v23, v23, v23
  v_lshlrev_b32 v23, 16, v23
  s_waitcnt vmcnt(11)
  s_waitcnt lgkmcnt(0)
  s_add_u32 s68, s70, 952
  s_sub_u32 s68, s68, s4
  s_cmpk_lt_i32 s68, 65496
  s_cbranch_scc1 L_fs35
  s_waitcnt vmcnt(7)
  s_cmpk_lt_i32 s68, 65521
  s_cbranch_scc1 L_fs35
  s_waitcnt vmcnt(4)
  s_cmpk_lt_i32 s68, 15
  s_cbranch_scc1 L_fs35
  s_waitcnt vmcnt(3)
  s_cmpk_lt_i32 s68, 40
  s_cbranch_scc1 L_fs35
  s_waitcnt vmcnt(2)
L_fs35:
  buffer_load_dwordx4 v[136:139], v3, s[48:51], s53 offen offset:2048 nt
  buffer_load_dwordx4 v[140:143], v3, s[48:51], s53 offen offset:3072 nt
  s_memrealtime s[4:5]
  v_mfma_f32_16x16x32_bf16 v[28:31], v[192:195], v[8:11], 0
  v_mfma_f32_16x16x32_bf16 v[32:35], v[196:199], v[8:11], 0
  v_mfma_f32_16x16x32_bf16 v[36:39], v[200:203], v[8:11], 0
  v_mfma_f32_16x16x32_bf16 v[40:43], v[204:207], v[8:11], 0
  s_nop 4
  v_mov_b32_dpp v44, v28 quad_perm:[0,1,2,3] row_mask:0xf bank_mask:0x1
  v_mov_b32_dpp v45, v29 row_ror:12 row_mask:0xf bank_mask:0x1
  v_mov_b32_dpp v46, v30 row_ror:8 row_mask:0xf bank_mask:0x1
  v_mov_b32_dpp v47, v31 row_ror:4 row_mask:0xf bank_mask:0x1
  v_mov_b32_dpp v44, v32 row_ror:4 row_mask:0xf bank_mask:0x2
  v_mov_b32_dpp v45, v33 quad_perm:[0,1,2,3] row_mask:0xf bank_mask:0x2
  v_mov_b32_dpp v46, v34 row_ror:12 row_mask:0xf bank_mask:0x2
  v_mov_b32_dpp v47, v35 row_ror:8 row_mask:0xf bank_mask:0x2
  v_mov_b32_dpp v44, v36 row_ror:8 row_mask:0xf bank_mask:0x4
  v_mov_b32_dpp v45, v37 row_ror:4 row_mask:0xf bank_mask:0x4
  v_mov_b32_dpp v46, v38 quad_perm:[0,1,2,3] row_mask:0xf bank_mask:0x4
  v_mov_b32_dpp v47, v39 row_ror:12 row_mask:0xf bank_mask:0x4
  v_mov_b32_dpp v44, v40 row_ror:12 row_mask:0xf bank_mask:0x8
  v_mov_b32_dpp v45, v41 row_ror:8 row_mask:0xf bank_mask:0x8
  v_mov_b32_dpp v46, v42 row_ror:4 row_mask:0xf bank_mask:0x8
  v_mov_b32_dpp v47, v43 quad_perm:[0,1,2,3] row_mask:0xf bank_mask:0x8
  v_add_f32 v44, v44, v45
  v_add_f32 v46, v46, v47
  v_add_f32 v24, v44, v46
  v_cvt_pk_bf16_f32 v24, v24, v24
  v_lshlrev_b32 v24, 16, v24
  v_mul_f32 v24, s56, v24
  v_cvt_pk_bf16_f32 v24, v24, v24
  v_lshlrev_b32 v24, 16, v24
  s_waitcnt vmcnt(11)
  s_waitcnt lgkmcnt(0)
  s_add_u32 s68, s70, 980
  s_sub_u32 s68, s68, s4
  s_cmpk_lt_i32 s68, 65496
  s_cbranch_scc1 L_fs36
  s_waitcnt vmcnt(6)
  s_cmpk_lt_i32 s68, 65521
  s_cbranch_scc1 L_fs36
  s_waitcnt vmcnt(4)
  s_cmpk_lt_i32 s68, 15
  s_cbranch_scc1 L_fs36
  s_waitcnt vmcnt(3)
  s_cmpk_lt_i32 s68, 40
  s_cbranch_scc1 L_fs36
  s_waitcnt vmcnt(2)
L_fs36:
  s_xor_b32 s53, s52, 196608
  buffer_load_dwordx4 v[144:147], v3, s[48:51], s53 offen offset:0 nt
  buffer_load_dwordx4 v[148:151], v3, s[48:51], s53 offen offset:1024 nt
  s_memrealtime s[4:5]
  s_load_dwordx16 s[16:31], s[40:41], 8960
  v_mfma_f32_16x16x32_bf16 v[28:31], v[208:211], v[8:11], 0
  v_mfma_f32_16x16x32_bf16 v[32:35], v[212:215], v[8:11], 0
  v_mfma_f32_16x16x32_bf16 v[36:39], v[216:219], v[8:11], 0
  v_mfma_f32_16x16x32_bf16 v[40:43], v[220:223], v[8:11], 0
  s_nop 4
  v_mov_b32_dpp v44, v28 quad_perm:[0,1,2,3] row_mask:0xf bank_mask:0x1
  v_mov_b32_dpp v45, v29 row_ror:12 row_mask:0xf bank_mask:0x1
  v_mov_b32_dpp v46, v30 row_ror:8 row_mask:0xf bank_mask:0x1
  v_mov_b32_dpp v47, v31 row_ror:4 row_mask:0xf bank_mask:0x1
  v_mov_b32_dpp v44, v32 row_ror:4 row_mask:0xf bank_mask:0x2
  v_mov_b32_dpp v45, v33 quad_perm:[0,1,2,3] row_mask:0xf bank_mask:0x2
  v_mov_b32_dpp v46, v34 row_ror:12 row_mask:0xf bank_mask:0x2
  v_mov_b32_dpp v47, v35 row_ror:8 row_mask:0xf bank_mask:0x2
  v_mov_b32_dpp v44, v36 row_ror:8 row_mask:0xf bank_mask:0x4
  v_mov_b32_dpp v45, v37 row_ror:4 row_mask:0xf bank_mask:0x4
  v_mov_b32_dpp v46, v38 quad_perm:[0,1,2,3] row_mask:0xf bank_mask:0x4
  v_mov_b32_dpp v47, v39 row_ror:12 row_mask:0xf bank_mask:0x4
  v_mov_b32_dpp v44, v40 row_ror:12 row_mask:0xf bank_mask:0x8
  v_mov_b32_dpp v45, v41 row_ror:8 row_mask:0xf bank_mask:0x8
  v_mov_b32_dpp v46, v42 row_ror:4 row_mask:0xf bank_mask:0x8
  v_mov_b32_dpp v47, v43 quad_perm:[0,1,2,3] row_mask:0xf bank_mask:0x8
  v_add_f32 v44, v44, v45
  v_add_f32 v46, v46, v47
  v_add_f32 v25, v44, v46
  v_cvt_pk_bf16_f32 v25, v25, v25
  v_lshlrev_b32 v25, 16, v25
  v_mul_f32 v25, s56, v25
  v_cvt_pk_bf16_f32 v25, v25, v25
  v_lshlrev_b32 v25, 16, v25
  s_waitcnt vmcnt(11)
  s_cmpk_lt_i32 s68, 65496
  s_cbranch_scc1 L_fs37
  s_waitcnt vmcnt(6)
  s_cmpk_lt_i32 s68, 65521
  s_cbranch_scc1 L_fs37
  s_waitcnt vmcnt(4)
  s_cmpk_lt_i32 s68, 15
  s_cbranch_scc1 L_fs37
  s_waitcnt vmcnt(3)
  s_cmpk_lt_i32 s68, 40
  s_cbranch_scc1 L_fs37
  s_waitcnt vmcnt(2)
L_fs37:
  buffer_load_dwordx4 v[152:155], v3, s[48:51], s53 offen offset:2048 nt
  buffer_load_dwordx4 v[156:159], v3, s[48:51], s53 offen offset:3072 nt
  v_mfma_f32_16x16x32_bf16 v[28:31], v[224:227], v[8:11], 0
  v_mfma_f32_16x16x32_bf16 v[32:35], v[228:231], v[8:11], 0
  v_mfma_f32_16x16x32_bf16 v[36:39], v[232:235], v[8:11], 0
  v_mfma_f32_16x16x32_bf16 v[40:43], v[236:239], v[8:11], 0
  s_nop 4
  v_mov_b32_dpp v44, v28 quad_perm:[0,1,2,3] row_mask:0xf bank_mask:0x1
  v_mov_b32_dpp v45, v29 row_ror:12 row_mask:0xf bank_mask:0x1
  v_mov_b32_dpp v46, v30 row_ror:8 row_mask:0xf bank_mask:0x1
  v_mov_b32_dpp v47, v31 row_ror:4 row_mask:0xf bank_mask:0x1
  v_mov_b32_dpp v44, v32 row_ror:4 row_mask:0xf bank_mask:0x2
  v_mov_b32_dpp v45, v33 quad_perm:[0,1,2,3] row_mask:0xf bank_mask:0x2
  v_mov_b32_dpp v46, v34 row_ror:12 row_mask:0xf bank_mask:0x2
  v_mov_b32_dpp v47, v35 row_ror:8 row_mask:0xf bank_mask:0x2
  v_mov_b32_dpp v44, v36 row_ror:8 row_mask:0xf bank_mask:0x4
  v_mov_b32_dpp v45, v37 row_ror:4 row_mask:0xf bank_mask:0x4
  v_mov_b32_dpp v46, v38 quad_perm:[0,1,2,3] row_mask:0xf bank_mask:0x4
  v_mov_b32_dpp v47, v39 row_ror:12 row_mask:0xf bank_mask:0x4
  v_mov_b32_dpp v44, v40 row_ror:12 row_mask:0xf bank_mask:0x8
  v_mov_b32_dpp v45, v41 row_ror:8 row_mask:0xf bank_mask:0x8
  v_mov_b32_dpp v46, v42 row_ror:4 row_mask:0xf bank_mask:0x8
  v_mov_b32_dpp v47, v43 quad_perm:[0,1,2,3] row_mask:0xf bank_mask:0x8
  v_add_f32 v44, v44, v45
  v_add_f32 v46, v46, v47
  v_add_f32 v26, v44, v46
  v_cvt_pk_bf16_f32 v26, v26, v26
  v_lshlrev_b32 v26, 16, v26
  v_mul_f32 v26, s56, v26
  v_cvt_pk_bf16_f32 v26, v26, v26
  v_lshlrev_b32 v26, 16, v26
  s_waitcnt vmcnt(10)
  s_cmpk_lt_i32 s68, 65496
  s_cbranch_scc1 L_fs38
  s_waitcnt vmcnt(6)
  s_cmpk_lt_i32 s68, 65521
  s_cbranch_scc1 L_fs38
  s_waitcnt vmcnt(4)
  s_cmpk_lt_i32 s68, 15
  s_cbranch_scc1 L_fs38
  s_waitcnt vmcnt(3)
  s_cmpk_lt_i32 s68, 40
  s_cbranch_scc1 L_fs38
  s_waitcnt vmcnt(2)
L_fs38:
  s_xor_b32 s53, s52, 262144
  buffer_load_dwordx4 v[160:163], v3, s[48:51], s53 offen offset:0 nt
  buffer_load_dwordx4 v[164:167], v3, s[48:51], s53 offen offset:1024 nt
  v_mfma_f32_16x16x32_bf16 v[28:31], v[240:243], v[8:11], 0
  v_mfma_f32_16x16x32_bf16 v[32:35], v[244:247], v[8:11], 0
  v_mfma_f32_16x16x32_bf16 v[36:39], v[248:251], v[8:11], 0
  v_mfma_f32_16x16x32_bf16 v[40:43], v[252:255], v[8:11], 0
  s_nop 4
  v_mov_b32_dpp v44, v28 quad_perm:[0,1,2,3] row_mask:0xf bank_mask:0x1
  v_mov_b32_dpp v45, v29 row_ror:12 row_mask:0xf bank_mask:0x1
  v_mov_b32_dpp v46, v30 row_ror:8 row_mask:0xf bank_mask:0x1
  v_mov_b32_dpp v47, v31 row_ror:4 row_mask:0xf bank_mask:0x1
  v_mov_b32_dpp v44, v32 row_ror:4 row_mask:0xf bank_mask:0x2
  v_mov_b32_dpp v45, v33 quad_perm:[0,1,2,3] row_mask:0xf bank_mask:0x2
  v_mov_b32_dpp v46, v34 row_ror:12 row_mask:0xf bank_mask:0x2
  v_mov_b32_dpp v47, v35 row_ror:8 row_mask:0xf bank_mask:0x2
  v_mov_b32_dpp v44, v36 row_ror:8 row_mask:0xf bank_mask:0x4
  v_mov_b32_dpp v45, v37 row_ror:4 row_mask:0xf bank_mask:0x4
  v_mov_b32_dpp v46, v38 quad_perm:[0,1,2,3] row_mask:0xf bank_mask:0x4
  v_mov_b32_dpp v47, v39 row_ror:12 row_mask:0xf bank_mask:0x4
  v_mov_b32_dpp v44, v40 row_ror:12 row_mask:0xf bank_mask:0x8
  v_mov_b32_dpp v45, v41 row_ror:8 row_mask:0xf bank_mask:0x8
  v_mov_b32_dpp v46, v42 row_ror:4 row_mask:0xf bank_mask:0x8
  v_mov_b32_dpp v47, v43 quad_perm:[0,1,2,3] row_mask:0xf bank_mask:0x8
  v_add_f32 v44, v44, v45
  v_add_f32 v46, v46, v47
  v_add_f32 v27, v44, v46
  v_cvt_pk_bf16_f32 v27, v27, v27
  v_lshlrev_b32 v27, 16, v27
  v_mul_f32 v27, s56, v27
  v_cvt_pk_bf16_f32 v27, v27, v27
  v_lshlrev_b32 v27, 16, v27
  s_waitcnt vmcnt(10)
  s_cmpk_lt_i32 s68, 65496
  s_cbranch_scc1 L_fs39
  s_waitcnt vmcnt(6)
  s_cmpk_lt_i32 s68, 65521
  s_cbranch_scc1 L_fs39
  s_waitcnt vmcnt(4)
  s_cmpk_lt_i32 s68, 15
  s_cbranch_scc1 L_fs39
  s_waitcnt vmcnt(3)
  s_cmpk_lt_i32 s68, 40
  s_cbranch_scc1 L_fs39
  s_waitcnt vmcnt(2)
L_fs39:
  buffer_load_dwordx4 v[168:171], v3, s[48:51], s53 offen offset:2048 nt
  buffer_load_dwordx4 v[172:175], v3, s[48:51], s53 offen offset:3072 nt
  s_movk_i32 s62, 868
  s_call_b64 s[80:81], L_cx
  s_memrealtime s[4:5]
  ds_read_b128 v[60:63], v86 offset:0
  ds_read_b128 v[64:67], v86 offset:1024
  ds_read_b128 v[68:71], v86 offset:2048
  ds_read_b128 v[72:75], v86 offset:3072
  s_waitcnt lgkmcnt(3)
  v_mfma_f32_16x16x32_bf16 v[28:31], v[60:63], v[8:11], 0
  s_waitcnt lgkmcnt(2)
  v_mfma_f32_16x16x32_bf16 v[32:35], v[64:67], v[8:11], 0
  s_waitcnt lgkmcnt(1)
  v_mfma_f32_16x16x32_bf16 v[36:39], v[68:71], v[8:11], 0
  s_waitcnt lgkmcnt(0)
  v_mfma_f32_16x16x32_bf16 v[40:43], v[72:75], v[8:11], 0
  s_nop 1
  v_mov_b32_dpp v44, v28 quad_perm:[0,1,2,3] row_mask:0xf bank_mask:0x1
  v_mov_b32_dpp v45, v29 row_ror:12 row_mask:0xf bank_mask:0x1
  v_mov_b32_dpp v46, v30 row_ror:8 row_mask:0xf bank_mask:0x1
  v_mov_b32_dpp v47, v31 row_ror:4 row_mask:0xf bank_mask:0x1
  v_mov_b32_dpp v44, v32 row_ror:4 row_mask:0xf bank_mask:0x2
  v_mov_b32_dpp v45, v33 quad_perm:[0,1,2,3] row_mask:0xf bank_mask:0x2
  v_mov_b32_dpp v46, v34 row_ror:12 row_mask:0xf bank_mask:0x2
  v_mov_b32_dpp v47, v35 row_ror:8 row_mask:0xf bank_mask:0x2
  v_mov_b32_dpp v44, v36 row_ror:8 row_mask:0xf bank_mask:0x4
  v_mov_b32_dpp v45, v37 row_ror:4 row_mask:0xf bank_mask:0x4
  v_mov_b32_dpp v46, v38 quad_perm:[0,1,2,3] row_mask:0xf bank_mask:0x4
  v_mov_b32_dpp v47, v39 row_ror:12 row_mask:0xf bank_mask:0x4
  v_mov_b32_dpp v44, v40 row_ror:12 row_mask:0xf bank_mask:0x8
  v_mov_b32_dpp v45, v41 row_ror:8 row_mask:0xf bank_mask:0x8
  v_mov_b32_dpp v46, v42 row_ror:4 row_mask:0xf bank_mask:0x8
  v_mov_b32_dpp v47, v43 quad_perm:[0,1,2,3] row_mask:0xf bank_mask:0x8
  v_add_f32 v44, v44, v45
  v_add_f32 v46, v46, v47
  v_add_f32 v12, v44, v46
  v_cvt_pk_bf16_f32 v12, v12, v12
  v_lshlrev_b32 v12, 16, v12
  v_mul_f32 v12, s56, v12
  v_cvt_pk_bf16_f32 v12, v12, v12
  v_lshlrev_b32 v12, 16, v12
  s_waitcnt vmcnt(10)
  s_waitcnt lgkmcnt(0)
  s_add_u32 s68, s70, 1092
  s_sub_u32 s68, s68, s4
  s_cmpk_lt_i32 s68, 65496
  s_cbranch_scc1 L_fs40
  s_waitcnt vmcnt(6)
  s_cmpk_lt_i32 s68, 65521
  s_cbranch_scc1 L_fs40
  s_waitcnt vmcnt(4)
  s_cmpk_lt_i32 s68, 15
  s_cbranch_scc1 L_fs40
  s_waitcnt vmcnt(3)
  s_cmpk_lt_i32 s68, 40
  s_cbranch_scc1 L_fs40
  s_waitcnt vmcnt(2)
L_fs40:
  s_xor_b32 s53, s52, 327680
  buffer_load_dwordx4 v[176:179], v3, s[48:51], s53 offen offset:0 nt
  buffer_load_dwordx4 v[180:183], v3, s[48:51], s53 offen offset:1024 nt
  s_memrealtime s[4:5]
  s_waitcnt lgkmcnt(0)
  v_mov_b32 v6, s4
  v_mov_b32 v7, s73
  s_movk_i32 s65, 9216
  s_cmp_eq_u32 s64, 23
  s_cselect_b64 exec, 1, 0
  buffer_store_dwordx2 v[6:7], v83, s[76:79], s65 offen sc1
  s_mov_b64 exec, -1
  ds_read_b128 v[60:63], v86 offset:4096
  ds_read_b128 v[64:67], v86 offset:5120
  ds_read_b128 v[68:71], v86 offset:6144
  ds_read_b128 v[72:75], v86 offset:7168
  s_waitcnt lgkmcnt(3)
  v_mfma_f32_16x16x32_bf16 v[28:31], v[60:63], v[8:11], 0
  s_waitcnt lgkmcnt(2)
  v_mfma_f32_16x16x32_bf16 v[32:35], v[64:67], v[8:11], 0
  s_waitcnt lgkmcnt(1)
  v_mfma_f32_16x16x32_bf16 v[36:39], v[68:71], v[8:11], 0
  s_waitcnt lgkmcnt(0)
  v_mfma_f32_16x16x32_bf16 v[40:43], v[72:75], v[8:11], 0
  s_nop 1
  v_mov_b32_dpp v44, v28 quad_perm:[0,1,2,3] row_mask:0xf bank_mask:0x1
  v_mov_b32_dpp v45, v29 row_ror:12 row_mask:0xf bank_mask:0x1
  v_mov_b32_dpp v46, v30 row_ror:8 row_mask:0xf bank_mask:0x1
  v_mov_b32_dpp v47, v31 row_ror:4 row_mask:0xf bank_mask:0x1
  v_mov_b32_dpp v44, v32 row_ror:4 row_mask:0xf bank_mask:0x2
  v_mov_b32_dpp v45, v33 quad_perm:[0,1,2,3] row_mask:0xf bank_mask:0x2
  v_mov_b32_dpp v46, v34 row_ror:12 row_mask:0xf bank_mask:0x2
  v_mov_b32_dpp v47, v35 row_ror:8 row_mask:0xf bank_mask:0x2
  v_mov_b32_dpp v44, v36 row_ror:8 row_mask:0xf bank_mask:0x4
  v_mov_b32_dpp v45, v37 row_ror:4 row_mask:0xf bank_mask:0x4
  v_mov_b32_dpp v46, v38 quad_perm:[0,1,2,3] row_mask:0xf bank_mask:0x4
  v_mov_b32_dpp v47, v39 row_ror:12 row_mask:0xf bank_mask:0x4
  v_mov_b32_dpp v44, v40 row_ror:12 row_mask:0xf bank_mask:0x8
  v_mov_b32_dpp v45, v41 row_ror:8 row_mask:0xf bank_mask:0x8
  v_mov_b32_dpp v46, v42 row_ror:4 row_mask:0xf bank_mask:0x8
  v_mov_b32_dpp v47, v43 quad_perm:[0,1,2,3] row_mask:0xf bank_mask:0x8
  v_add_f32 v44, v44, v45
  v_add_f32 v46, v46, v47
  v_add_f32 v13, v44, v46
  v_cvt_pk_bf16_f32 v13, v13, v13
  v_lshlrev_b32 v13, 16, v13
  v_mul_f32 v13, s56, v13
  v_cvt_pk_bf16_f32 v13, v13, v13
  v_lshlrev_b32 v13, 16, v13
  s_waitcnt vmcnt(11)
  s_waitcnt lgkmcnt(0)
  s_add_u32 s68, s70, 1120
  s_sub_u32 s68, s68, s4
  s_cmpk_lt_i32 s68, 65496
  s_cbranch_scc1 L_fs41
  s_waitcnt vmcnt(7)
  s_cmpk_lt_i32 s68, 65521
  s_cbranch_scc1 L_fs41
  s_waitcnt vmcnt(5)
  s_cmpk_lt_i32 s68, 15
  s_cbranch_scc1 L_fs41
  s_waitcnt vmcnt(4)
  s_cmpk_lt_i32 s68, 40
  s_cbranch_scc1 L_fs41
  s_waitcnt vmcnt(3)
L_fs41:
  buffer_load_dwordx4 v[184:187], v3, s[48:51], s53 offen offset:2048 nt
  buffer_load_dwordx4 v[188:191], v3, s[48:51], s53 offen offset:3072 nt
  s_memrealtime s[4:5]
  ds_read_b128 v[60:63], v86 offset:8192
  ds_read_b128 v[64:67], v86 offset:9216
  ds_read_b128 v[68:71], v86 offset:10240
  ds_read_b128 v[72:75], v86 offset:11264
  s_waitcnt lgkmcnt(3)
  v_mfma_f32_16x16x32_bf16 v[28:31], v[60:63], v[8:11], 0
  s_waitcnt lgkmcnt(2)
  v_mfma_f32_16x16x32_bf16 v[32:35], v[64:67], v[8:11], 0
  s_waitcnt lgkmcnt(1)
  v_mfma_f32_16x16x32_bf16 v[36:39], v[68:71], v[8:11], 0
  s_waitcnt lgkmcnt(0)
  v_mfma_f32_16x16x32_bf16 v[40:43], v[72:75], v[8:11], 0
  s_nop 1
  v_mov_b32_dpp v44, v28 quad_perm:[0,1,2,3] row_mask:0xf bank_mask:0x1
  v_mov_b32_dpp v45, v29 row_ror:12 row_mask:0xf bank_mask:0x1
  v_mov_b32_dpp v46, v30 row_ror:8 row_mask:0xf bank_mask:0x1
  v_mov_b32_dpp v47, v31 row_ror:4 row_mask:0xf bank_mask:0x1
  v_mov_b32_dpp v44, v32 row_ror:4 row_mask:0xf bank_mask:0x2
  v_mov_b32_dpp v45, v33 quad_perm:[0,1,2,3] row_mask:0xf bank_mask:0x2
  v_mov_b32_dpp v46, v34 row_ror:12 row_mask:0xf bank_mask:0x2
  v_mov_b32_dpp v47, v35 row_ror:8 row_mask:0xf bank_mask:0x2
  v_mov_b32_dpp v44, v36 row_ror:8 row_mask:0xf bank_mask:0x4
  v_mov_b32_dpp v45, v37 row_ror:4 row_mask:0xf bank_mask:0x4
  v_mov_b32_dpp v46, v38 quad_perm:[0,1,2,3] row_mask:0xf bank_mask:0x4
  v_mov_b32_dpp v47, v39 row_ror:12 row_mask:0xf bank_mask:0x4
  v_mov_b32_dpp v44, v40 row_ror:12 row_mask:0xf bank_mask:0x8
  v_mov_b32_dpp v45, v41 row_ror:8 row_mask:0xf bank_mask:0x8
  v_mov_b32_dpp v46, v42 row_ror:4 row_mask:0xf bank_mask:0x8
  v_mov_b32_dpp v47, v43 quad_perm:[0,1,2,3] row_mask:0xf bank_mask:0x8
  v_add_f32 v44, v44, v45
  v_add_f32 v46, v46, v47
  v_add_f32 v14, v44, v46
  v_cvt_pk_bf16_f32 v14, v14, v14
  v_lshlrev_b32 v14, 16, v14
  v_mul_f32 v14, s56, v14
  v_cvt_pk_bf16_f32 v14, v14, v14
  v_lshlrev_b32 v14, 16, v14
  s_waitcnt vmcnt(11)
  s_waitcnt lgkmcnt(0)
  s_add_u32 s68, s70, 1148
  s_sub_u32 s68, s68, s4
  s_cmpk_lt_i32 s68, 65496
  s_cbranch_scc1 L_fs42
  s_waitcnt vmcnt(7)
  s_cmpk_lt_i32 s68, 65521
  s_cbranch_scc1 L_fs42
  s_waitcnt vmcnt(5)
  s_cmpk_lt_i32 s68, 15
  s_cbranch_scc1 L_fs42
  s_waitcnt vmcnt(4)
  s_cmpk_lt_i32 s68, 40
  s_cbranch_scc1 L_fs42
  s_waitcnt vmcnt(3)
L_fs42:
  s_xor_b32 s53, s52, 393216
  buffer_load_dwordx4 v[192:195], v3, s[48:51], s53 offen offset:0 nt
  buffer_load_dwordx4 v[196:199], v3, s[48:51], s53 offen offset:1024 nt
  s_memrealtime s[4:5]
  ds_read_b128 v[60:63], v86 offset:12288
  ds_read_b128 v[64:67], v86 offset:13312
  ds_read_b128 v[68:71], v86 offset:14336
  ds_read_b128 v[72:75], v86 offset:15360
  s_waitcnt lgkmcnt(3)
  v_mfma_f32_16x16x32_bf16 v[28:31], v[60:63], v[8:11], 0
  s_waitcnt lgkmcnt(2)
  v_mfma_f32_16x16x32_bf16 v[32:35], v[64:67], v[8:11], 0
  s_waitcnt lgkmcnt(1)
  v_mfma_f32_16x16x32_bf16 v[36:39], v[68:71], v[8:11], 0
  s_waitcnt lgkmcnt(0)
  v_mfma_f32_16x16x32_bf16 v[40:43], v[72:75], v[8:11], 0
  s_nop 1
  v_mov_b32_dpp v44, v28 quad_perm:[0,1,2,3] row_mask:0xf bank_mask:0x1
  v_mov_b32_dpp v45, v29 row_ror:12 row_mask:0xf bank_mask:0x1
  v_mov_b32_dpp v46, v30 row_ror:8 row_mask:0xf bank_mask:0x1
  v_mov_b32_dpp v47, v31 row_ror:4 row_mask:0xf bank_mask:0x1
  v_mov_b32_dpp v44, v32 row_ror:4 row_mask:0xf bank_mask:0x2
  v_mov_b32_dpp v45, v33 quad_perm:[0,1,2,3] row_mask:0xf bank_mask:0x2
  v_mov_b32_dpp v46, v34 row_ror:12 row_mask:0xf bank_mask:0x2
  v_mov_b32_dpp v47, v35 row_ror:8 row_mask:0xf bank_mask:0x2
  v_mov_b32_dpp v44, v36 row_ror:8 row_mask:0xf bank_mask:0x4
  v_mov_b32_dpp v45, v37 row_ror:4 row_mask:0xf bank_mask:0x4
  v_mov_b32_dpp v46, v38 quad_perm:[0,1,2,3] row_mask:0xf bank_mask:0x4
  v_mov_b32_dpp v47, v39 row_ror:12 row_mask:0xf bank_mask:0x4
  v_mov_b32_dpp v44, v40 row_ror:12 row_mask:0xf bank_mask:0x8
  v_mov_b32_dpp v45, v41 row_ror:8 row_mask:0xf bank_mask:0x8
  v_mov_b32_dpp v46, v42 row_ror:4 row_mask:0xf bank_mask:0x8
  v_mov_b32_dpp v47, v43 quad_perm:[0,1,2,3] row_mask:0xf bank_mask:0x8
  v_add_f32 v44, v44, v45
  v_add_f32 v46, v46, v47
  v_add_f32 v15, v44, v46
  v_cvt_pk_bf16_f32 v15, v15, v15
  v_lshlrev_b32 v15, 16, v15
  v_mul_f32 v15, s56, v15
  v_cvt_pk_bf16_f32 v15, v15, v15
  v_lshlrev_b32 v15, 16, v15
  s_waitcnt vmcnt(11)
  s_waitcnt lgkmcnt(0)
  s_add_u32 s68, s70, 1176
  s_sub_u32 s68, s68, s4
  s_cmpk_lt_i32 s68, 65496
  s_cbranch_scc1 L_fs43
  s_waitcnt vmcnt(7)
  s_cmpk_lt_i32 s68, 65521
  s_cbranch_scc1 L_fs43
  s_waitcnt vmcnt(5)
  s_cmpk_lt_i32 s68, 15
  s_cbranch_scc1 L_fs43
  s_waitcnt vmcnt(3)
  s_cmpk_lt_i32 s68, 40
  s_cbranch_scc1 L_fs43
  s_waitcnt vmcnt(2)
L_fs43:
  buffer_load_dwordx4 v[200:203], v3, s[48:51], s53 offen offset:2048 nt
  buffer_load_dwordx4 v[204:207], v3, s[48:51], s53 offen offset:3072 nt
  s_memrealtime s[4:5]
  ds_read_b128 v[60:63], v86 offset:16384
  ds_read_b128 v[64:67], v86 offset:17408
  ds_read_b128 v[68:71], v86 offset:18432
  ds_read_b128 v[72:75], v86 offset:19456
  s_waitcnt lgkmcnt(3)
  v_mfma_f32_16x16x32_bf16 v[28:31], v[60:63], v[8:11], 0
  s_waitcnt lgkmcnt(2)
  v_mfma_f32_16x16x32_bf16 v[32:35], v[64:67], v[8:11], 0
  s_waitcnt lgkmcnt(1)
  v_mfma_f32_16x16x32_bf16 v[36:39], v[68:71], v[8:11], 0
  s_waitcnt lgkmcnt(0)
  v_mfma_f32_16x16x32_bf16 v[40:43], v[72:75], v[8:11], 0
  s_nop 1
  v_mov_b32_dpp v44, v28 quad_perm:[0,1,2,3] row_mask:0xf bank_mask:0x1
  v_mov_b32_dpp v45, v29 row_ror:12 row_mask:0xf bank_mask:0x1
  v_mov_b32_dpp v46, v30 row_ror:8 row_mask:0xf bank_mask:0x1
  v_mov_b32_dpp v47, v31 row_ror:4 row_mask:0xf bank_mask:0x1
  v_mov_b32_dpp v44, v32 row_ror:4 row_mask:0xf bank_mask:0x2
  v_mov_b32_dpp v45, v33 quad_perm:[0,1,2,3] row_mask:0xf bank_mask:0x2
  v_mov_b32_dpp v46, v34 row_ror:12 row_mask:0xf bank_mask:0x2
  v_mov_b32_dpp v47, v35 row_ror:8 row_mask:0xf bank_mask:0x2
  v_mov_b32_dpp v44, v36 row_ror:8 row_mask:0xf bank_mask:0x4
  v_mov_b32_dpp v45, v37 row_ror:4 row_mask:0xf bank_mask:0x4
  v_mov_b32_dpp v46, v38 quad_perm:[0,1,2,3] row_mask:0xf bank_mask:0x4
  v_mov_b32_dpp v47, v39 row_ror:12 row_mask:0xf bank_mask:0x4
  v_mov_b32_dpp v44, v40 row_ror:12 row_mask:0xf bank_mask:0x8
  v_mov_b32_dpp v45, v41 row_ror:8 row_mask:0xf bank_mask:0x8
  v_mov_b32_dpp v46, v42 row_ror:4 row_mask:0xf bank_mask:0x8
  v_mov_b32_dpp v47, v43 quad_perm:[0,1,2,3] row_mask:0xf bank_mask:0x8
  v_add_f32 v44, v44, v45
  v_add_f32 v46, v46, v47
  v_add_f32 v16, v44, v46
  v_cvt_pk_bf16_f32 v16, v16, v16
  v_lshlrev_b32 v16, 16, v16
  v_mul_f32 v16, s56, v16
  v_cvt_pk_bf16_f32 v16, v16, v16
  v_lshlrev_b32 v16, 16, v16
  s_waitcnt vmcnt(11)
  s_waitcnt lgkmcnt(0)
  s_add_u32 s68, s70, 1204
  s_sub_u32 s68, s68, s4
  s_cmpk_lt_i32 s68, 65496
  s_cbranch_scc1 L_fs44
  s_waitcnt vmcnt(7)
  s_cmpk_lt_i32 s68, 65521
  s_cbranch_scc1 L_fs44
  s_waitcnt vmcnt(4)
  s_cmpk_lt_i32 s68, 15
  s_cbranch_scc1 L_fs44
  s_waitcnt vmcnt(3)
  s_cmpk_lt_i32 s68, 40
  s_cbranch_scc1 L_fs44
  s_waitcnt vmcnt(2)
L_fs44:
  s_xor_b32 s53, s52, 458752
  buffer_load_dwordx4 v[208:211], v3, s[48:51], s53 offen offset:0 nt
  buffer_load_dwordx4 v[212:215], v3, s[48:51], s53 offen offset:1024 nt
  s_memrealtime s[4:5]
  ds_read_b128 v[60:63], v86 offset:20480
  ds_read_b128 v[64:67], v86 offset:21504
  ds_read_b128 v[68:71], v86 offset:22528
  ds_read_b128 v[72:75], v86 offset:23552
  s_waitcnt lgkmcnt(3)
  v_mfma_f32_16x16x32_bf16 v[28:31], v[60:63], v[8:11], 0
  s_waitcnt lgkmcnt(2)
  v_mfma_f32_16x16x32_bf16 v[32:35], v[64:67], v[8:11], 0
  s_waitcnt lgkmcnt(1)
  v_mfma_f32_16x16x32_bf16 v[36:39], v[68:71], v[8:11], 0
  s_waitcnt lgkmcnt(0)
  v_mfma_f32_16x16x32_bf16 v[40:43], v[72:75], v[8:11], 0
  s_nop 1
  v_mov_b32_dpp v44, v28 quad_perm:[0,1,2,3] row_mask:0xf bank_mask:0x1
  v_mov_b32_dpp v45, v29 row_ror:12 row_mask:0xf bank_mask:0x1
  v_mov_b32_dpp v46, v30 row_ror:8 row_mask:0xf bank_mask:0x1
  v_mov_b32_dpp v47, v31 row_ror:4 row_mask:0xf bank_mask:0x1
  v_mov_b32_dpp v44, v32 row_ror:4 row_mask:0xf bank_mask:0x2
  v_mov_b32_dpp v45, v33 quad_perm:[0,1,2,3] row_mask:0xf bank_mask:0x2
  v_mov_b32_dpp v46, v34 row_ror:12 row_mask:0xf bank_mask:0x2
  v_mov_b32_dpp v47, v35 row_ror:8 row_mask:0xf bank_mask:0x2
  v_mov_b32_dpp v44, v36 row_ror:8 row_mask:0xf bank_mask:0x4
  v_mov_b32_dpp v45, v37 row_ror:4 row_mask:0xf bank_mask:0x4
  v_mov_b32_dpp v46, v38 quad_perm:[0,1,2,3] row_mask:0xf bank_mask:0x4
  v_mov_b32_dpp v47, v39 row_ror:12 row_mask:0xf bank_mask:0x4
  v_mov_b32_dpp v44, v40 row_ror:12 row_mask:0xf bank_mask:0x8
  v_mov_b32_dpp v45, v41 row_ror:8 row_mask:0xf bank_mask:0x8
  v_mov_b32_dpp v46, v42 row_ror:4 row_mask:0xf bank_mask:0x8
  v_mov_b32_dpp v47, v43 quad_perm:[0,1,2,3] row_mask:0xf bank_mask:0x8
  v_add_f32 v44, v44, v45
  v_add_f32 v46, v46, v47
  v_add_f32 v17, v44, v46
  v_cvt_pk_bf16_f32 v17, v17, v17
  v_lshlrev_b32 v17, 16, v17
  v_mul_f32 v17, s56, v17
  v_cvt_pk_bf16_f32 v17, v17, v17
  v_lshlrev_b32 v17, 16, v17
  s_waitcnt vmcnt(11)
  s_waitcnt lgkmcnt(0)
  s_add_u32 s68, s70, 1232
  s_sub_u32 s68, s68, s4
  s_cmpk_lt_i32 s68, 65496
  s_cbranch_scc1 L_fs45
  s_waitcnt vmcnt(6)
  s_cmpk_lt_i32 s68, 65521
  s_cbranch_scc1 L_fs45
  s_waitcnt vmcnt(4)
  s_cmpk_lt_i32 s68, 15
  s_cbranch_scc1 L_fs45
  s_waitcnt vmcnt(3)
  s_cmpk_lt_i32 s68, 40
  s_cbranch_scc1 L_fs45
  s_waitcnt vmcnt(2)
L_fs45:
  buffer_load_dwordx4 v[216:219], v3, s[48:51], s53 offen offset:2048 nt
  buffer_load_dwordx4 v[220:223], v3, s[48:51], s53 offen offset:3072 nt
  s_memrealtime s[4:5]
  s_load_dwordx16 s[16:31], s[40:41], 9216
  v_max3_f32 v80, v12, v13, v14
  v_max3_f32 v80, v80, v15, v16
  v_max3_f32 v80, v80, v17, v18
  v_max3_f32 v80, v80, v19, v20
  v_max3_f32 v80, v80, v21, v22
  v_max3_f32 v80, v80, v23, v24
  v_max3_f32 v80, v80, v25, v26
  v_max_f32 v80, v80, v27
  s_nop 1
  v_max_f32_dpp v80, v80, v80 row_ror:4 row_mask:0xf bank_mask:0xf
  s_nop 1
  v_max_f32_dpp v80, v80, v80 row_ror:8 row_mask:0xf bank_mask:0xf
  v_mov_b32 v82, v80
  s_nop 1
  v_permlane16_swap_b32 v80, v82
  v_max_f32 v80, v80, v82
  v_mov_b32 v82, v80
  s_nop 1
  v_permlane32_swap_b32 v80, v82
  v_max_f32 v80, v80, v82
  v_mul_f32 v80, s57, v80
  v_fma_f32 v12, v12, s57, -v80
  v_fma_f32 v13, v13, s57, -v80
  v_fma_f32 v14, v14, s57, -v80
  v_fma_f32 v15, v15, s57, -v80
  v_fma_f32 v16, v16, s57, -v80
  v_fma_f32 v17, v17, s57, -v80
  v_fma_f32 v18, v18, s57, -v80
  v_fma_f32 v19, v19, s57, -v80
  v_fma_f32 v20, v20, s57, -v80
  v_fma_f32 v21, v21, s57, -v80
  v_fma_f32 v22, v22, s57, -v80
  v_fma_f32 v23, v23, s57, -v80
  v_fma_f32 v24, v24, s57, -v80
  v_fma_f32 v25, v25, s57, -v80
  v_fma_f32 v26, v26, s57, -v80
  v_fma_f32 v27, v27, s57, -v80
  v_exp_f32 v12, v12
  v_exp_f32 v13, v13
  v_exp_f32 v14, v14
  v_exp_f32 v15, v15
  v_exp_f32 v16, v16
  v_exp_f32 v17, v17
  v_exp_f32 v18, v18
  v_exp_f32 v19, v19
  v_exp_f32 v20, v20
  v_exp_f32 v21, v21
  v_exp_f32 v22, v22
  v_exp_f32 v23, v23
  v_exp_f32 v24, v24
  v_exp_f32 v25, v25
  v_exp_f32 v26, v26
  v_exp_f32 v27, v27
  v_add_f32 v81, v12, v13
  v_add_f32 v82, v14, v15
  v_add_f32 v81, v81, v16
  v_add_f32 v82, v82, v17
  v_add_f32 v81, v81, v18
  v_add_f32 v82, v82, v19
  v_add_f32 v81, v81, v20
  v_add_f32 v82, v82, v21
  v_add_f32 v81, v81, v22
  v_add_f32 v82, v82, v23
  v_add_f32 v81, v81, v24
  v_add_f32 v82, v82, v25
  v_add_f32 v81, v81, v26
  v_add_f32 v82, v82, v27
  v_add_f32 v81, v81, v82
  v_cvt_pk_bf16_f32 v12, v12, v13
  v_cvt_pk_bf16_f32 v13, v14, v15
  v_cvt_pk_bf16_f32 v14, v16, v17
  v_cvt_pk_bf16_f32 v15, v18, v19
  v_cvt_pk_bf16_f32 v16, v20, v21
  v_cvt_pk_bf16_f32 v17, v22, v23
  v_cvt_pk_bf16_f32 v18, v24, v25
  v_cvt_pk_bf16_f32 v19, v26, v27
  v_mov_b32 v36, 0
  v_mov_b32 v37, 0
  v_mov_b32 v38, 0
  v_mov_b32 v39, 0
  v_mov_b32 v40, 0
  v_mov_b32 v41, 0
  v_mov_b32 v42, 0
  v_mov_b32 v43, 0
  v_mov_b32 v44, 0
  v_mov_b32 v45, 0
  v_mov_b32 v46, 0
  v_mov_b32 v47, 0
  v_mov_b32 v48, 0
  v_mov_b32 v49, 0
  v_mov_b32 v50, 0
  v_mov_b32 v51, 0
  v_add_f32_dpp v81, v81, v81 row_ror:4 row_mask:0xf bank_mask:0xf
  s_nop 1
  v_add_f32_dpp v81, v81, v81 row_ror:8 row_mask:0xf bank_mask:0xf
  v_mov_b32 v82, v81
  s_nop 1
  v_permlane16_swap_b32 v81, v82
  v_add_f32 v81, v81, v82
  v_mov_b32 v82, v81
  s_nop 1
  v_permlane32_swap_b32 v81, v82
  v_add_f32 v81, v81, v82
  s_lshl_b32 s59, s3, 5
  v_lshl_add_u32 v82, v1, 3, s59
  s_mov_b64 exec, 15
  ds_write_b64 v82, v[80:81] offset:1088
  s_mov_b64 exec, 1
  v_mov_b32 v82, 1
  ds_add_u32 v84, v82 offset:16
  s_mov_b64 exec, -1
  s_waitcnt vmcnt(11)
  s_cmpk_lt_i32 s68, 65496
  s_cbranch_scc1 L_fs46
  s_waitcnt vmcnt(6)
  s_cmpk_lt_i32 s68, 65521
  s_cbranch_scc1 L_fs46
  s_waitcnt vmcnt(4)
  s_cmpk_lt_i32 s68, 15
  s_cbranch_scc1 L_fs46
  s_waitcnt vmcnt(3)
  s_cmpk_lt_i32 s68, 40
  s_cbranch_scc1 L_fs46
  s_waitcnt vmcnt(2)
L_fs46:
  s_xor_b32 s53, s52, 524288
  buffer_load_dwordx4 v[224:227], v3, s[48:51], s53 offen offset:0 nt
  buffer_load_dwordx4 v[228:231], v3, s[48:51], s53 offen offset:1024 nt
  v_mov_b32_dpp v36, v12 quad_perm:[0,1,2,3] row_mask:0xf bank_mask:0x1
  v_mov_b32_dpp v37, v12 row_ror:12 row_mask:0xf bank_mask:0x1
  v_mov_b32_dpp v38, v12 row_ror:8 row_mask:0xf bank_mask:0x1
  v_mov_b32_dpp v39, v12 row_ror:4 row_mask:0xf bank_mask:0x1
  v_mov_b32_dpp v40, v12 row_ror:4 row_mask:0xf bank_mask:0x2
  v_mov_b32_dpp v41, v12 quad_perm:[0,1,2,3] row_mask:0xf bank_mask:0x2
  v_mov_b32_dpp v42, v12 row_ror:12 row_mask:0xf bank_mask:0x2
  v_mov_b32_dpp v43, v12 row_ror:8 row_mask:0xf bank_mask:0x2
  v_mov_b32_dpp v44, v12 row_ror:8 row_mask:0xf bank_mask:0x4
  v_mov_b32_dpp v45, v12 row_ror:4 row_mask:0xf bank_mask:0x4
  v_mov_b32_dpp v46, v12 quad_perm:[0,1,2,3] row_mask:0xf bank_mask:0x4
  v_mov_b32_dpp v47, v12 row_ror:12 row_mask:0xf bank_mask:0x4
  v_mov_b32_dpp v48, v12 row_ror:12 row_mask:0xf bank_mask:0x8
  v_mov_b32_dpp v49, v12 row_ror:8 row_mask:0xf bank_mask:0x8
  v_mov_b32_dpp v50, v12 row_ror:4 row_mask:0xf bank_mask:0x8
  v_mov_b32_dpp v51, v12 quad_perm:[0,1,2,3] row_mask:0xf bank_mask:0x8
  v_perm_b32 v60, v112, v96, s54
  v_perm_b32 v61, v116, v100, s54
  v_perm_b32 v62, v120, v104, s54
  v_perm_b32 v63, v124, v108, s54
  v_perm_b32 v64, v112, v96, s55
  v_perm_b32 v65, v116, v100, s55
  v_perm_b32 v66, v120, v104, s55
  v_perm_b32 v67, v124, v108, s55
  v_perm_b32 v68, v113, v97, s54
  v_perm_b32 v69, v117, v101, s54
  v_perm_b32 v70, v121, v105, s54
  v_perm_b32 v71, v125, v109, s54
  v_perm_b32 v72, v113, v97, s55
  v_perm_b32 v73, v117, v101, s55
  v_perm_b32 v74, v121, v105, s55
  v_perm_b32 v75, v125, v109, s55
  v_mfma_f32_16x16x32_bf16 v[28:31], v[36:39], v[60:63], 0
  v_mfma_f32_16x16x32_bf16 v[28:31], v[40:43], v[64:67], v[28:31]
  v_mfma_f32_16x16x32_bf16 v[28:31], v[44:47], v[68:71], v[28:31]
  v_mfma_f32_16x16x32_bf16 v[28:31], v[48:51], v[72:75], v[28:31]
  v_perm_b32 v60, v114, v98, s54
  v_perm_b32 v61, v118, v102, s54
  v_perm_b32 v62, v122, v106, s54
  v_perm_b32 v63, v126, v110, s54
  v_perm_b32 v64, v114, v98, s55
  v_perm_b32 v65, v118, v102, s55
  v_perm_b32 v66, v122, v106, s55
  v_perm_b32 v67, v126, v110, s55
  v_perm_b32 v68, v115, v99, s54
  v_perm_b32 v69, v119, v103, s54
  v_perm_b32 v70, v123, v107, s54
  v_perm_b32 v71, v127, v111, s54
  v_perm_b32 v72, v115, v99, s55
  v_perm_b32 v73, v119, v103, s55
  v_perm_b32 v74, v123, v107, s55
  v_perm_b32 v75, v127, v111, s55
  v_mfma_f32_16x16x32_bf16 v[32:35], v[36:39], v[60:63], 0
  v_mfma_f32_16x16x32_bf16 v[32:35], v[40:43], v[64:67], v[32:35]
  v_mfma_f32_16x16x32_bf16 v[32:35], v[44:47], v[68:71], v[32:35]
  v_mfma_f32_16x16x32_bf16 v[32:35], v[48:51], v[72:75], v[32:35]
  s_waitcnt vmcnt(10)
  s_cmpk_lt_i32 s68, 65496
  s_cbranch_scc1 L_fs47
  s_waitcnt vmcnt(6)
  s_cmpk_lt_i32 s68, 65521
  s_cbranch_scc1 L_fs47
  s_waitcnt vmcnt(4)
  s_cmpk_lt_i32 s68, 15
  s_cbranch_scc1 L_fs47
  s_waitcnt vmcnt(3)
  s_cmpk_lt_i32 s68, 40
  s_cbranch_scc1 L_fs47
  s_waitcnt vmcnt(2)
L_fs47:
  buffer_load_dwordx4 v[232:235], v3, s[48:51], s53 offen offset:2048 nt
  buffer_load_dwordx4 v[236:239], v3, s[48:51], s53 offen offset:3072 nt
  v_mov_b32_dpp v36, v13 quad_perm:[0,1,2,3] row_mask:0xf bank_mask:0x1
  v_mov_b32_dpp v37, v13 row_ror:12 row_mask:0xf bank_mask:0x1
  v_mov_b32_dpp v38, v13 row_ror:8 row_mask:0xf bank_mask:0x1
  v_mov_b32_dpp v39, v13 row_ror:4 row_mask:0xf bank_mask:0x1
  v_mov_b32_dpp v40, v13 row_ror:4 row_mask:0xf bank_mask:0x2
  v_mov_b32_dpp v41, v13 quad_perm:[0,1,2,3] row_mask:0xf bank_mask:0x2
  v_mov_b32_dpp v42, v13 row_ror:12 row_mask:0xf bank_mask:0x2
  v_mov_b32_dpp v43, v13 row_ror:8 row_mask:0xf bank_mask:0x2
  v_mov_b32_dpp v44, v13 row_ror:8 row_mask:0xf bank_mask:0x4
  v_mov_b32_dpp v45, v13 row_ror:4 row_mask:0xf bank_mask:0x4
  v_mov_b32_dpp v46, v13 quad_perm:[0,1,2,3] row_mask:0xf bank_mask:0x4
  v_mov_b32_dpp v47, v13 row_ror:12 row_mask:0xf bank_mask:0x4
  v_mov_b32_dpp v48, v13 row_ror:12 row_mask:0xf bank_mask:0x8
  v_mov_b32_dpp v49, v13 row_ror:8 row_mask:0xf bank_mask:0x8
  v_mov_b32_dpp v50, v13 row_ror:4 row_mask:0xf bank_mask:0x8
  v_mov_b32_dpp v51, v13 quad_perm:[0,1,2,3] row_mask:0xf bank_mask:0x8
  v_perm_b32 v60, v144, v128, s54
  v_perm_b32 v61, v148, v132, s54
  v_perm_b32 v62, v152, v136, s54
  v_perm_b32 v63, v156, v140, s54
  v_perm_b32 v64, v144, v128, s55
  v_perm_b32 v65, v148, v132, s55
  v_perm_b32 v66, v152, v136, s55
  v_perm_b32 v67, v156, v140, s55
  v_perm_b32 v68, v145, v129, s54
  v_perm_b32 v69, v149, v133, s54
  v_perm_b32 v70, v153, v137, s54
  v_perm_b32 v71, v157, v141, s54
  v_perm_b32 v72, v145, v129, s55
  v_perm_b32 v73, v149, v133, s55
  v_perm_b32 v74, v153, v137, s55
  v_perm_b32 v75, v157, v141, s55
  v_mfma_f32_16x16x32_bf16 v[28:31], v[36:39], v[60:63], v[28:31]
  v_mfma_f32_16x16x32_bf16 v[28:31], v[40:43], v[64:67], v[28:31]
  v_mfma_f32_16x16x32_bf16 v[28:31], v[44:47], v[68:71], v[28:31]
  v_mfma_f32_16x16x32_bf16 v[28:31], v[48:51], v[72:75], v[28:31]
  v_perm_b32 v60, v146, v130, s54
  v_perm_b32 v61, v150, v134, s54
  v_perm_b32 v62, v154, v138, s54
  v_perm_b32 v63, v158, v142, s54
  v_perm_b32 v64, v146, v130, s55
  v_perm_b32 v65, v150, v134, s55
  v_perm_b32 v66, v154, v138, s55
  v_perm_b32 v67, v158, v142, s55
  v_perm_b32 v68, v147, v131, s54
  v_perm_b32 v69, v151, v135, s54
  v_perm_b32 v70, v155, v139, s54
  v_perm_b32 v71, v159, v143, s54
  v_perm_b32 v72, v147, v131, s55
  v_perm_b32 v73, v151, v135, s55
  v_perm_b32 v74, v155, v139, s55
  v_perm_b32 v75, v159, v143, s55
  v_mfma_f32_16x16x32_bf16 v[32:35], v[36:39], v[60:63], v[32:35]
  v_mfma_f32_16x16x32_bf16 v[32:35], v[40:43], v[64:67], v[32:35]
  v_mfma_f32_16x16x32_bf16 v[32:35], v[44:47], v[68:71], v[32:35]
  v_mfma_f32_16x16x32_bf16 v[32:35], v[48:51], v[72:75], v[32:35]
  s_waitcnt vmcnt(10)
  s_cmpk_lt_i32 s68, 65496
  s_cbranch_scc1 L_fs48
  s_waitcnt vmcnt(6)
  s_cmpk_lt_i32 s68, 65521
  s_cbranch_scc1 L_fs48
  s_waitcnt vmcnt(4)
  s_cmpk_lt_i32 s68, 15
  s_cbranch_scc1 L_fs48
  s_waitcnt vmcnt(3)
  s_cmpk_lt_i32 s68, 40
  s_cbranch_scc1 L_fs48
  s_waitcnt vmcnt(2)
L_fs48:
  s_xor_b32 s53, s52, 589824
  buffer_load_dwordx4 v[240:243], v3, s[48:51], s53 offen offset:0 nt
  buffer_load_dwordx4 v[244:247], v3, s[48:51], s53 offen offset:1024 nt
  s_movk_i32 s62, 1120
  s_call_b64 s[80:81], L_cx
  s_memrealtime s[4:5]
  v_mov_b32_dpp v36, v14 quad_perm:[0,1,2,3] row_mask:0xf bank_mask:0x1
  v_mov_b32_dpp v37, v14 row_ror:12 row_mask:0xf bank_mask:0x1
  v_mov_b32_dpp v38, v14 row_ror:8 row_mask:0xf bank_mask:0x1
  v_mov_b32_dpp v39, v14 row_ror:4 row_mask:0xf bank_mask:0x1
  v_mov_b32_dpp v40, v14 row_ror:4 row_mask:0xf bank_mask:0x2
  v_mov_b32_dpp v41, v14 quad_perm:[0,1,2,3] row_mask:0xf bank_mask:0x2
  v_mov_b32_dpp v42, v14 row_ror:12 row_mask:0xf bank_mask:0x2
  v_mov_b32_dpp v43, v14 row_ror:8 row_mask:0xf bank_mask:0x2
  v_mov_b32_dpp v44, v14 row_ror:8 row_mask:0xf bank_mask:0x4
  v_mov_b32_dpp v45, v14 row_ror:4 row_mask:0xf bank_mask:0x4
  v_mov_b32_dpp v46, v14 quad_perm:[0,1,2,3] row_mask:0xf bank_mask:0x4
  v_mov_b32_dpp v47, v14 row_ror:12 row_mask:0xf bank_mask:0x4
  v_mov_b32_dpp v48, v14 row_ror:12 row_mask:0xf bank_mask:0x8
  v_mov_b32_dpp v49, v14 row_ror:8 row_mask:0xf bank_mask:0x8
  v_mov_b32_dpp v50, v14 row_ror:4 row_mask:0xf bank_mask:0x8
  v_mov_b32_dpp v51, v14 quad_perm:[0,1,2,3] row_mask:0xf bank_mask:0x8
  v_perm_b32 v60, v176, v160, s54
  v_perm_b32 v61, v180, v164, s54
  v_perm_b32 v62, v184, v168, s54
  v_perm_b32 v63, v188, v172, s54
  v_perm_b32 v64, v176, v160, s55
  v_perm_b32 v65, v180, v164, s55
  v_perm_b32 v66, v184, v168, s55
  v_perm_b32 v67, v188, v172, s55
  v_perm_b32 v68, v177, v161, s54
  v_perm_b32 v69, v181, v165, s54
  v_perm_b32 v70, v185, v169, s54
  v_perm_b32 v71, v189, v173, s54
  v_perm_b32 v72, v177, v161, s55
  v_perm_b32 v73, v181, v165, s55
  v_perm_b32 v74, v185, v169, s55
  v_perm_b32 v75, v189, v173, s55
  v_mfma_f32_16x16x32_bf16 v[28:31], v[36:39], v[60:63], v[28:31]
  v_mfma_f32_16x16x32_bf16 v[28:31], v[40:43], v[64:67], v[28:31]
  v_mfma_f32_16x16x32_bf16 v[28:31], v[44:47], v[68:71], v[28:31]
  v_mfma_f32_16x16x32_bf16 v[28:31], v[48:51], v[72:75], v[28:31]
  v_perm_b32 v60, v178, v162, s54
  v_perm_b32 v61, v182, v166, s54
  v_perm_b32 v62, v186, v170, s54
  v_perm_b32 v63, v190, v174, s54
  v_perm_b32 v64, v178, v162, s55
  v_perm_b32 v65, v182, v166, s55
  v_perm_b32 v66, v186, v170, s55
  v_perm_b32 v67, v190, v174, s55
  v_perm_b32 v68, v179, v163, s54
  v_perm_b32 v69, v183, v167, s54
  v_perm_b32 v70, v187, v171, s54
  v_perm_b32 v71, v191, v175, s54
  v_perm_b32 v72, v179, v163, s55
  v_perm_b32 v73, v183, v167, s55
  v_perm_b32 v74, v187, v171, s55
  v_perm_b32 v75, v191, v175, s55
  v_mfma_f32_16x16x32_bf16 v[32:35], v[36:39], v[60:63], v[32:35]
  v_mfma_f32_16x16x32_bf16 v[32:35], v[40:43], v[64:67], v[32:35]
  v_mfma_f32_16x16x32_bf16 v[32:35], v[44:47], v[68:71], v[32:35]
  v_mfma_f32_16x16x32_bf16 v[32:35], v[48:51], v[72:75], v[32:35]
  s_waitcnt vmcnt(10)
  s_waitcnt lgkmcnt(0)
  s_add_u32 s68, s70, 1344
  s_sub_u32 s68, s68, s4
  s_cmpk_lt_i32 s68, 65496
  s_cbranch_scc1 L_fs49
  s_waitcnt vmcnt(6)
  s_cmpk_lt_i32 s68, 65521
  s_cbranch_scc1 L_fs49
  s_waitcnt vmcnt(4)
  s_cmpk_lt_i32 s68, 15
  s_cbranch_scc1 L_fs49
  s_waitcnt vmcnt(3)
  s_cmpk_lt_i32 s68, 40
  s_cbranch_scc1 L_fs49
  s_waitcnt vmcnt(2)
L_fs49:
  buffer_load_dwordx4 v[248:251], v3, s[48:51], s53 offen offset:2048 nt
  buffer_load_dwordx4 v[252:255], v3, s[48:51], s53 offen offset:3072 nt
  s_memrealtime s[4:5]
  s_waitcnt lgkmcnt(0)
  v_mov_b32 v6, s4
  v_mov_b32 v7, s73
  s_movk_i32 s65, 9472
  s_cmp_eq_u32 s64, 28
  s_cselect_b64 exec, 1, 0
  buffer_store_dwordx2 v[6:7], v83, s[76:79], s65 offen sc1
  s_mov_b64 exec, -1
  s_waitcnt vmcnt(11)
  s_waitcnt lgkmcnt(0)
  s_add_u32 s68, s70, 1372
  s_sub_u32 s68, s68, s4
  s_cmpk_lt_i32 s68, 65496
  s_cbranch_scc1 L_fs50
  s_waitcnt vmcnt(7)
  s_cmpk_lt_i32 s68, 65521
  s_cbranch_scc1 L_fs50
  s_waitcnt vmcnt(5)
  s_cmpk_lt_i32 s68, 15
  s_cbranch_scc1 L_fs50
  s_waitcnt vmcnt(4)
  s_cmpk_lt_i32 s68, 40
  s_cbranch_scc1 L_fs50
  s_waitcnt vmcnt(3)
L_fs50:
  s_xor_b32 s53, s52, 655360
  buffer_load_dwordx4 v[96:99], v3, s[48:51], s53 offen offset:0 nt
  buffer_load_dwordx4 v[100:103], v3, s[48:51], s53 offen offset:1024 nt
  s_memrealtime s[4:5]
  s_waitcnt vmcnt(11)
  s_waitcnt lgkmcnt(0)
  s_add_u32 s68, s70, 1400
  s_sub_u32 s68, s68, s4
  s_cmpk_lt_i32 s68, 65496
  s_cbranch_scc1 L_fs51
  s_waitcnt vmcnt(7)
  s_cmpk_lt_i32 s68, 65521
  s_cbranch_scc1 L_fs51
  s_waitcnt vmcnt(5)
  s_cmpk_lt_i32 s68, 15
  s_cbranch_scc1 L_fs51
  s_waitcnt vmcnt(4)
  s_cmpk_lt_i32 s68, 40
  s_cbranch_scc1 L_fs51
  s_waitcnt vmcnt(3)
L_fs51:
  buffer_load_dwordx4 v[104:107], v3, s[48:51], s53 offen offset:2048 nt
  buffer_load_dwordx4 v[108:111], v3, s[48:51], s53 offen offset:3072 nt
  s_memrealtime s[4:5]
  v_mov_b32_dpp v36, v15 quad_perm:[0,1,2,3] row_mask:0xf bank_mask:0x1
  v_mov_b32_dpp v37, v15 row_ror:12 row_mask:0xf bank_mask:0x1
  v_mov_b32_dpp v38, v15 row_ror:8 row_mask:0xf bank_mask:0x1
  v_mov_b32_dpp v39, v15 row_ror:4 row_mask:0xf bank_mask:0x1
  v_mov_b32_dpp v40, v15 row_ror:4 row_mask:0xf bank_mask:0x2
  v_mov_b32_dpp v41, v15 quad_perm:[0,1,2,3] row_mask:0xf bank_mask:0x2
  v_mov_b32_dpp v42, v15 row_ror:12 row_mask:0xf bank_mask:0x2
  v_mov_b32_dpp v43, v15 row_ror:8 row_mask:0xf bank_mask:0x2
  v_mov_b32_dpp v44, v15 row_ror:8 row_mask:0xf bank_mask:0x4
  v_mov_b32_dpp v45, v15 row_ror:4 row_mask:0xf bank_mask:0x4
  v_mov_b32_dpp v46, v15 quad_perm:[0,1,2,3] row_mask:0xf bank_mask:0x4
  v_mov_b32_dpp v47, v15 row_ror:12 row_mask:0xf bank_mask:0x4
  v_mov_b32_dpp v48, v15 row_ror:12 row_mask:0xf bank_mask:0x8
  v_mov_b32_dpp v49, v15 row_ror:8 row_mask:0xf bank_mask:0x8
  v_mov_b32_dpp v50, v15 row_ror:4 row_mask:0xf bank_mask:0x8
  v_mov_b32_dpp v51, v15 quad_perm:[0,1,2,3] row_mask:0xf bank_mask:0x8
  v_perm_b32 v60, v208, v192, s54
  v_perm_b32 v61, v212, v196, s54
  v_perm_b32 v62, v216, v200, s54
  v_perm_b32 v63, v220, v204, s54
  v_perm_b32 v64, v208, v192, s55
  v_perm_b32 v65, v212, v196, s55
  v_perm_b32 v66, v216, v200, s55
  v_perm_b32 v67, v220, v204, s55
  v_perm_b32 v68, v209, v193, s54
  v_perm_b32 v69, v213, v197, s54
  v_perm_b32 v70, v217, v201, s54
  v_perm_b32 v71, v221, v205, s54
  v_perm_b32 v72, v209, v193, s55
  v_perm_b32 v73, v213, v197, s55
  v_perm_b32 v74, v217, v201, s55
  v_perm_b32 v75, v221, v205, s55
  v_mfma_f32_16x16x32_bf16 v[28:31], v[36:39], v[60:63], v[28:31]
  v_mfma_f32_16x16x32_bf16 v[28:31], v[40:43], v[64:67], v[28:31]
  v_mfma_f32_16x16x32_bf16 v[28:31], v[44:47], v[68:71], v[28:31]
  v_mfma_f32_16x16x32_bf16 v[28:31], v[48:51], v[72:75], v[28:31]
  v_perm_b32 v60, v210, v194, s54
  v_perm_b32 v61, v214, v198, s54
  v_perm_b32 v62, v218, v202, s54
  v_perm_b32 v63, v222, v206, s54
  v_perm_b32 v64, v210, v194, s55
  v_perm_b32 v65, v214, v198, s55
  v_perm_b32 v66, v218, v202, s55
  v_perm_b32 v67, v222, v206, s55
  v_perm_b32 v68, v211, v195, s54
  v_perm_b32 v69, v215, v199, s54
  v_perm_b32 v70, v219, v203, s54
  v_perm_b32 v71, v223, v207, s54
  v_perm_b32 v72, v211, v195, s55
  v_perm_b32 v73, v215, v199, s55
  v_perm_b32 v74, v219, v203, s55
  v_perm_b32 v75, v223, v207, s55
  v_mfma_f32_16x16x32_bf16 v[32:35], v[36:39], v[60:63], v[32:35]
  v_mfma_f32_16x16x32_bf16 v[32:35], v[40:43], v[64:67], v[32:35]
  v_mfma_f32_16x16x32_bf16 v[32:35], v[44:47], v[68:71], v[32:35]
  v_mfma_f32_16x16x32_bf16 v[32:35], v[48:51], v[72:75], v[32:35]
  s_waitcnt vmcnt(11)
  s_waitcnt lgkmcnt(0)
  s_add_u32 s68, s70, 1428
  s_sub_u32 s68, s68, s4
  s_cmpk_lt_i32 s68, 65496
  s_cbranch_scc1 L_fs52
  s_waitcnt vmcnt(7)
  s_cmpk_lt_i32 s68, 65521
  s_cbranch_scc1 L_fs52
  s_waitcnt vmcnt(5)
  s_cmpk_lt_i32 s68, 15
  s_cbranch_scc1 L_fs52
  s_waitcnt vmcnt(3)
  s_cmpk_lt_i32 s68, 40
  s_cbranch_scc1 L_fs52
  s_waitcnt vmcnt(2)
L_fs52:
  s_xor_b32 s53, s52, 720896
  buffer_load_dwordx4 v[112:115], v3, s[48:51], s53 offen offset:0 nt
  buffer_load_dwordx4 v[116:119], v3, s[48:51], s53 offen offset:1024 nt
  s_memrealtime s[4:5]
  s_waitcnt vmcnt(11)
  s_waitcnt lgkmcnt(0)
  s_add_u32 s68, s70, 1456
  s_sub_u32 s68, s68, s4
  s_cmpk_lt_i32 s68, 65496
  s_cbranch_scc1 L_fs53
  s_waitcnt vmcnt(7)
  s_cmpk_lt_i32 s68, 65521
  s_cbranch_scc1 L_fs53
  s_waitcnt vmcnt(4)
  s_cmpk_lt_i32 s68, 15
  s_cbranch_scc1 L_fs53
  s_waitcnt vmcnt(3)
  s_cmpk_lt_i32 s68, 40
  s_cbranch_scc1 L_fs53
  s_waitcnt vmcnt(2)
L_fs53:
  buffer_load_dwordx4 v[120:123], v3, s[48:51], s53 offen offset:2048 nt
  buffer_load_dwordx4 v[124:127], v3, s[48:51], s53 offen offset:3072 nt
  s_memrealtime s[4:5]
  s_waitcnt vmcnt(11)
  s_waitcnt lgkmcnt(0)
  s_add_u32 s68, s70, 1484
  s_sub_u32 s68, s68, s4
  s_cmpk_lt_i32 s68, 65496
  s_cbranch_scc1 L_fs54
  s_waitcnt vmcnt(6)
  s_cmpk_lt_i32 s68, 65521
  s_cbranch_scc1 L_fs54
  s_waitcnt vmcnt(4)
  s_cmpk_lt_i32 s68, 15
  s_cbranch_scc1 L_fs54
  s_waitcnt vmcnt(3)
  s_cmpk_lt_i32 s68, 40
  s_cbranch_scc1 L_fs54
  s_waitcnt vmcnt(2)
L_fs54:
  s_xor_b32 s53, s52, 786432
  buffer_load_dwordx4 v[128:131], v3, s[48:51], s53 offen offset:0 nt
  buffer_load_dwordx4 v[132:135], v3, s[48:51], s53 offen offset:1024 nt
  s_memrealtime s[4:5]
  s_load_dwordx16 s[16:31], s[40:41], 9472
  s_waitcnt vmcnt(11)
  s_cmpk_lt_i32 s68, 65496
  s_cbranch_scc1 L_fs55
  s_waitcnt vmcnt(6)
  s_cmpk_lt_i32 s68, 65521
  s_cbranch_scc1 L_fs55
  s_waitcnt vmcnt(4)
  s_cmpk_lt_i32 s68, 15
  s_cbranch_scc1 L_fs55
  s_waitcnt vmcnt(3)
  s_cmpk_lt_i32 s68, 40
  s_cbranch_scc1 L_fs55
  s_waitcnt vmcnt(2)
L_fs55:
  buffer_load_dwordx4 v[136:139], v3, s[48:51], s53 offen offset:2048 nt
  buffer_load_dwordx4 v[140:143], v3, s[48:51], s53 offen offset:3072 nt
  v_mov_b32_dpp v36, v16 quad_perm:[0,1,2,3] row_mask:0xf bank_mask:0x1
  v_mov_b32_dpp v37, v16 row_ror:12 row_mask:0xf bank_mask:0x1
  v_mov_b32_dpp v38, v16 row_ror:8 row_mask:0xf bank_mask:0x1
  v_mov_b32_dpp v39, v16 row_ror:4 row_mask:0xf bank_mask:0x1
  v_mov_b32_dpp v40, v16 row_ror:4 row_mask:0xf bank_mask:0x2
  v_mov_b32_dpp v41, v16 quad_perm:[0,1,2,3] row_mask:0xf bank_mask:0x2
  v_mov_b32_dpp v42, v16 row_ror:12 row_mask:0xf bank_mask:0x2
  v_mov_b32_dpp v43, v16 row_ror:8 row_mask:0xf bank_mask:0x2
  v_mov_b32_dpp v44, v16 row_ror:8 row_mask:0xf bank_mask:0x4
  v_mov_b32_dpp v45, v16 row_ror:4 row_mask:0xf bank_mask:0x4
  v_mov_b32_dpp v46, v16 quad_perm:[0,1,2,3] row_mask:0xf bank_mask:0x4
  v_mov_b32_dpp v47, v16 row_ror:12 row_mask:0xf bank_mask:0x4
  v_mov_b32_dpp v48, v16 row_ror:12 row_mask:0xf bank_mask:0x8
  v_mov_b32_dpp v49, v16 row_ror:8 row_mask:0xf bank_mask:0x8
  v_mov_b32_dpp v50, v16 row_ror:4 row_mask:0xf bank_mask:0x8
  v_mov_b32_dpp v51, v16 quad_perm:[0,1,2,3] row_mask:0xf bank_mask:0x8
  v_perm_b32 v60, v240, v224, s54
  v_perm_b32 v61, v244, v228, s54
  v_perm_b32 v62, v248, v232, s54
  v_perm_b32 v63, v252, v236, s54
  v_perm_b32 v64, v240, v224, s55
  v_perm_b32 v65, v244, v228, s55
  v_perm_b32 v66, v248, v232, s55
  v_perm_b32 v67, v252, v236, s55
  v_perm_b32 v68, v241, v225, s54
  v_perm_b32 v69, v245, v229, s54
  v_perm_b32 v70, v249, v233, s54
  v_perm_b32 v71, v253, v237, s54
  v_perm_b32 v72, v241, v225, s55
  v_perm_b32 v73, v245, v229, s55
  v_perm_b32 v74, v249, v233, s55
  v_perm_b32 v75, v253, v237, s55
  v_mfma_f32_16x16x32_bf16 v[28:31], v[36:39], v[60:63], v[28:31]
  v_mfma_f32_16x16x32_bf16 v[28:31], v[40:43], v[64:67], v[28:31]
  v_mfma_f32_16x16x32_bf16 v[28:31], v[44:47], v[68:71], v[28:31]
  v_mfma_f32_16x16x32_bf16 v[28:31], v[48:51], v[72:75], v[28:31]
  v_perm_b32 v60, v242, v226, s54
  v_perm_b32 v61, v246, v230, s54
  v_perm_b32 v62, v250, v234, s54
  v_perm_b32 v63, v254, v238, s54
  v_perm_b32 v64, v242, v226, s55
  v_perm_b32 v65, v246, v230, s55
  v_perm_b32 v66, v250, v234, s55
  v_perm_b32 v67, v254, v238, s55
  v_perm_b32 v68, v243, v227, s54
  v_perm_b32 v69, v247, v231, s54
  v_perm_b32 v70, v251, v235, s54
  v_perm_b32 v71, v255, v239, s54
  v_perm_b32 v72, v243, v227, s55
  v_perm_b32 v73, v247, v231, s55
  v_perm_b32 v74, v251, v235, s55
  v_perm_b32 v75, v255, v239, s55
  v_mfma_f32_16x16x32_bf16 v[32:35], v[36:39], v[60:63], v[32:35]
  v_mfma_f32_16x16x32_bf16 v[32:35], v[40:43], v[64:67], v[32:35]
  v_mfma_f32_16x16x32_bf16 v[32:35], v[44:47], v[68:71], v[32:35]
  v_mfma_f32_16x16x32_bf16 v[32:35], v[48:51], v[72:75], v[32:35]
  s_waitcnt vmcnt(10)
  s_cmpk_lt_i32 s68, 65496
  s_cbranch_scc1 L_fs56
  s_waitcnt vmcnt(6)
  s_cmpk_lt_i32 s68, 65521
  s_cbranch_scc1 L_fs56
  s_waitcnt vmcnt(4)
  s_cmpk_lt_i32 s68, 15
  s_cbranch_scc1 L_fs56
  s_waitcnt vmcnt(3)
  s_cmpk_lt_i32 s68, 40
  s_cbranch_scc1 L_fs56
  s_waitcnt vmcnt(2)
L_fs56:
  s_xor_b32 s53, s52, 851968
  buffer_load_dwordx4 v[144:147], v3, s[48:51], s53 offen offset:0 nt
  buffer_load_dwordx4 v[148:151], v3, s[48:51], s53 offen offset:1024 nt
  s_waitcnt vmcnt(10)
  s_cmpk_lt_i32 s68, 65496
  s_cbranch_scc1 L_fs57
  s_waitcnt vmcnt(6)
  s_cmpk_lt_i32 s68, 65521
  s_cbranch_scc1 L_fs57
  s_waitcnt vmcnt(4)
  s_cmpk_lt_i32 s68, 15
  s_cbranch_scc1 L_fs57
  s_waitcnt vmcnt(3)
  s_cmpk_lt_i32 s68, 40
  s_cbranch_scc1 L_fs57
  s_waitcnt vmcnt(2)
L_fs57:
  buffer_load_dwordx4 v[152:155], v3, s[48:51], s53 offen offset:2048 nt
  buffer_load_dwordx4 v[156:159], v3, s[48:51], s53 offen offset:3072 nt
  s_movk_i32 s62, 1372
  s_call_b64 s[80:81], L_cx
  s_memrealtime s[4:5]
  s_waitcnt vmcnt(10)
  s_waitcnt lgkmcnt(0)
  s_add_u32 s68, s70, 1596
  s_sub_u32 s68, s68, s4
  s_cmpk_lt_i32 s68, 65496
  s_cbranch_scc1 L_fs58
  s_waitcnt vmcnt(6)
  s_cmpk_lt_i32 s68, 65521
  s_cbranch_scc1 L_fs58
  s_waitcnt vmcnt(4)
  s_cmpk_lt_i32 s68, 15
  s_cbranch_scc1 L_fs58
  s_waitcnt vmcnt(3)
  s_cmpk_lt_i32 s68, 40
  s_cbranch_scc1 L_fs58
  s_waitcnt vmcnt(2)
L_fs58:
  s_xor_b32 s53, s52, 917504
  buffer_load_dwordx4 v[160:163], v3, s[48:51], s53 offen offset:0 nt
  buffer_load_dwordx4 v[164:167], v3, s[48:51], s53 offen offset:1024 nt
  s_memrealtime s[4:5]
  s_waitcnt vmcnt(10)
  s_waitcnt lgkmcnt(0)
  s_add_u32 s68, s70, 1624
  s_sub_u32 s68, s68, s4
  s_cmpk_lt_i32 s68, 65496
  s_cbranch_scc1 L_fs59
  s_waitcnt vmcnt(6)
  s_cmpk_lt_i32 s68, 65521
  s_cbranch_scc1 L_fs59
  s_waitcnt vmcnt(4)
  s_cmpk_lt_i32 s68, 15
  s_cbranch_scc1 L_fs59
  s_waitcnt vmcnt(3)
  s_cmpk_lt_i32 s68, 40
  s_cbranch_scc1 L_fs59
  s_waitcnt vmcnt(2)
L_fs59:
  buffer_load_dwordx4 v[168:171], v3, s[48:51], s53 offen offset:2048 nt
  buffer_load_dwordx4 v[172:175], v3, s[48:51], s53 offen offset:3072 nt
  s_memrealtime s[4:5]
  v_mov_b32_dpp v36, v17 quad_perm:[0,1,2,3] row_mask:0xf bank_mask:0x1
  v_mov_b32_dpp v37, v17 row_ror:12 row_mask:0xf bank_mask:0x1
  v_mov_b32_dpp v38, v17 row_ror:8 row_mask:0xf bank_mask:0x1
  v_mov_b32_dpp v39, v17 row_ror:4 row_mask:0xf bank_mask:0x1
  v_mov_b32_dpp v40, v17 row_ror:4 row_mask:0xf bank_mask:0x2
  v_mov_b32_dpp v41, v17 quad_perm:[0,1,2,3] row_mask:0xf bank_mask:0x2
  v_mov_b32_dpp v42, v17 row_ror:12 row_mask:0xf bank_mask:0x2
  v_mov_b32_dpp v43, v17 row_ror:8 row_mask:0xf bank_mask:0x2
  v_mov_b32_dpp v44, v17 row_ror:8 row_mask:0xf bank_mask:0x4
  v_mov_b32_dpp v45, v17 row_ror:4 row_mask:0xf bank_mask:0x4
  v_mov_b32_dpp v46, v17 quad_perm:[0,1,2,3] row_mask:0xf bank_mask:0x4
  v_mov_b32_dpp v47, v17 row_ror:12 row_mask:0xf bank_mask:0x4
  v_mov_b32_dpp v48, v17 row_ror:12 row_mask:0xf bank_mask:0x8
  v_mov_b32_dpp v49, v17 row_ror:8 row_mask:0xf bank_mask:0x8
  v_mov_b32_dpp v50, v17 row_ror:4 row_mask:0xf bank_mask:0x8
  v_mov_b32_dpp v51, v17 quad_perm:[0,1,2,3] row_mask:0xf bank_mask:0x8
  v_perm_b32 v60, v112, v96, s54
  v_perm_b32 v61, v116, v100, s54
  v_perm_b32 v62, v120, v104, s54
  v_perm_b32 v63, v124, v108, s54
  v_perm_b32 v64, v112, v96, s55
  v_perm_b32 v65, v116, v100, s55
  v_perm_b32 v66, v120, v104, s55
  v_perm_b32 v67, v124, v108, s55
  v_perm_b32 v68, v113, v97, s54
  v_perm_b32 v69, v117, v101, s54
  v_perm_b32 v70, v121, v105, s54
  v_perm_b32 v71, v125, v109, s54
  v_perm_b32 v72, v113, v97, s55
  v_perm_b32 v73, v117, v101, s55
  v_perm_b32 v74, v121, v105, s55
  v_perm_b32 v75, v125, v109, s55
  v_mfma_f32_16x16x32_bf16 v[28:31], v[36:39], v[60:63], v[28:31]
  v_mfma_f32_16x16x32_bf16 v[28:31], v[40:43], v[64:67], v[28:31]
  v_mfma_f32_16x16x32_bf16 v[28:31], v[44:47], v[68:71], v[28:31]
  v_mfma_f32_16x16x32_bf16 v[28:31], v[48:51], v[72:75], v[28:31]
  v_perm_b32 v60, v114, v98, s54
  v_perm_b32 v61, v118, v102, s54
  v_perm_b32 v62, v122, v106, s54
  v_perm_b32 v63, v126, v110, s54
  v_perm_b32 v64, v114, v98, s55
  v_perm_b32 v65, v118, v102, s55
  v_perm_b32 v66, v122, v106, s55
  v_perm_b32 v67, v126, v110, s55
  v_perm_b32 v68, v115, v99, s54
  v_perm_b32 v69, v119, v103, s54
  v_perm_b32 v70, v123, v107, s54
  v_perm_b32 v71, v127, v111, s54
  v_perm_b32 v72, v115, v99, s55
  v_perm_b32 v73, v119, v103, s55
  v_perm_b32 v74, v123, v107, s55
  v_perm_b32 v75, v127, v111, s55
  v_mfma_f32_16x16x32_bf16 v[32:35], v[36:39], v[60:63], v[32:35]
  v_mfma_f32_16x16x32_bf16 v[32:35], v[40:43], v[64:67], v[32:35]
  v_mfma_f32_16x16x32_bf16 v[32:35], v[44:47], v[68:71], v[32:35]
  v_mfma_f32_16x16x32_bf16 v[32:35], v[48:51], v[72:75], v[32:35]
  s_waitcnt vmcnt(10)
  s_waitcnt lgkmcnt(0)
  s_add_u32 s68, s70, 1652
  s_sub_u32 s68, s68, s4
  s_cmpk_lt_i32 s68, 65496
  s_cbranch_scc1 L_fs60
  s_waitcnt vmcnt(6)
  s_cmpk_lt_i32 s68, 65521
  s_cbranch_scc1 L_fs60
  s_waitcnt vmcnt(4)
  s_cmpk_lt_i32 s68, 15
  s_cbranch_scc1 L_fs60
  s_waitcnt vmcnt(3)
  s_cmpk_lt_i32 s68, 40
  s_cbranch_scc1 L_fs60
  s_waitcnt vmcnt(2)
L_fs60:
  s_xor_b32 s53, s52, 983040
  buffer_load_dwordx4 v[176:179], v3, s[48:51], s53 offen offset:0 nt
  buffer_load_dwordx4 v[180:183], v3, s[48:51], s53 offen offset:1024 nt
  s_memrealtime s[4:5]
  s_waitcnt vmcnt(10)
  s_waitcnt lgkmcnt(0)
  s_add_u32 s68, s70, 1680
  s_sub_u32 s68, s68, s4
  s_cmpk_lt_i32 s68, 65496
  s_cbranch_scc1 L_fs61
  s_waitcnt vmcnt(6)
  s_cmpk_lt_i32 s68, 65521
  s_cbranch_scc1 L_fs61
  s_waitcnt vmcnt(4)
  s_cmpk_lt_i32 s68, 15
  s_cbranch_scc1 L_fs61
  s_waitcnt vmcnt(3)
  s_cmpk_lt_i32 s68, 40
  s_cbranch_scc1 L_fs61
  s_waitcnt vmcnt(2)
L_fs61:
  buffer_load_dwordx4 v[184:187], v3, s[48:51], s53 offen offset:2048 nt
  buffer_load_dwordx4 v[188:191], v3, s[48:51], s53 offen offset:3072 nt
  s_memrealtime s[4:5]
  s_waitcnt vmcnt(8)
  v_mov_b32_dpp v36, v18 quad_perm:[0,1,2,3] row_mask:0xf bank_mask:0x1
  v_mov_b32_dpp v37, v18 row_ror:12 row_mask:0xf bank_mask:0x1
  v_mov_b32_dpp v38, v18 row_ror:8 row_mask:0xf bank_mask:0x1
  v_mov_b32_dpp v39, v18 row_ror:4 row_mask:0xf bank_mask:0x1
  v_mov_b32_dpp v40, v18 row_ror:4 row_mask:0xf bank_mask:0x2
  v_mov_b32_dpp v41, v18 quad_perm:[0,1,2,3] row_mask:0xf bank_mask:0x2
  v_mov_b32_dpp v42, v18 row_ror:12 row_mask:0xf bank_mask:0x2
  v_mov_b32_dpp v43, v18 row_ror:8 row_mask:0xf bank_mask:0x2
  v_mov_b32_dpp v44, v18 row_ror:8 row_mask:0xf bank_mask:0x4
  v_mov_b32_dpp v45, v18 row_ror:4 row_mask:0xf bank_mask:0x4
  v_mov_b32_dpp v46, v18 quad_perm:[0,1,2,3] row_mask:0xf bank_mask:0x4
  v_mov_b32_dpp v47, v18 row_ror:12 row_mask:0xf bank_mask:0x4
  v_mov_b32_dpp v48, v18 row_ror:12 row_mask:0xf bank_mask:0x8
  v_mov_b32_dpp v49, v18 row_ror:8 row_mask:0xf bank_mask:0x8
  v_mov_b32_dpp v50, v18 row_ror:4 row_mask:0xf bank_mask:0x8
  v_mov_b32_dpp v51, v18 quad_perm:[0,1,2,3] row_mask:0xf bank_mask:0x8
  v_perm_b32 v60, v144, v128, s54
  v_perm_b32 v61, v148, v132, s54
  v_perm_b32 v62, v152, v136, s54
  v_perm_b32 v63, v156, v140, s54
  v_perm_b32 v64, v144, v128, s55
  v_perm_b32 v65, v148, v132, s55
  v_perm_b32 v66, v152, v136, s55
  v_perm_b32 v67, v156, v140, s55
  v_perm_b32 v68, v145, v129, s54
  v_perm_b32 v69, v149, v133, s54
  v_perm_b32 v70, v153, v137, s54
  v_perm_b32 v71, v157, v141, s54
  v_perm_b32 v72, v145, v129, s55
  v_perm_b32 v73, v149, v133, s55
  v_perm_b32 v74, v153, v137, s55
  v_perm_b32 v75, v157, v141, s55
  v_mfma_f32_16x16x32_bf16 v[28:31], v[36:39], v[60:63], v[28:31]
  v_mfma_f32_16x16x32_bf16 v[28:31], v[40:43], v[64:67], v[28:31]
  v_mfma_f32_16x16x32_bf16 v[28:31], v[44:47], v[68:71], v[28:31]
  v_mfma_f32_16x16x32_bf16 v[28:31], v[48:51], v[72:75], v[28:31]
  v_perm_b32 v60, v146, v130, s54
  v_perm_b32 v61, v150, v134, s54
  v_perm_b32 v62, v154, v138, s54
  v_perm_b32 v63, v158, v142, s54
  v_perm_b32 v64, v146, v130, s55
  v_perm_b32 v65, v150, v134, s55
  v_perm_b32 v66, v154, v138, s55
  v_perm_b32 v67, v158, v142, s55
  v_perm_b32 v68, v147, v131, s54
  v_perm_b32 v69, v151, v135, s54
  v_perm_b32 v70, v155, v139, s54
  v_perm_b32 v71, v159, v143, s54
  v_perm_b32 v72, v147, v131, s55
  v_perm_b32 v73, v151, v135, s55
  v_perm_b32 v74, v155, v139, s55
  v_perm_b32 v75, v159, v143, s55
  v_mfma_f32_16x16x32_bf16 v[32:35], v[36:39], v[60:63], v[32:35]
  v_mfma_f32_16x16x32_bf16 v[32:35], v[40:43], v[64:67], v[32:35]
  v_mfma_f32_16x16x32_bf16 v[32:35], v[44:47], v[68:71], v[32:35]
  v_mfma_f32_16x16x32_bf16 v[32:35], v[48:51], v[72:75], v[32:35]
  s_waitcnt vmcnt(3)
  s_mov_b64 exec, 1
  v_mov_b32 v82, 1
  ds_add_u32 v84, v82 offset:28
  s_mov_b64 exec, -1
  s_lshl_b32 s59, s3, 11
  v_add_u32 v4, s59, v3
  v_mov_b32 v82, 1
  v_mov_b32_dpp v36, v19 quad_perm:[0,1,2,3] row_mask:0xf bank_mask:0x1
  v_mov_b32_dpp v37, v19 row_ror:12 row_mask:0xf bank_mask:0x1
  v_mov_b32_dpp v38, v19 row_ror:8 row_mask:0xf bank_mask:0x1
  v_mov_b32_dpp v39, v19 row_ror:4 row_mask:0xf bank_mask:0x1
  v_mov_b32_dpp v40, v19 row_ror:4 row_mask:0xf bank_mask:0x2
  v_mov_b32_dpp v41, v19 quad_perm:[0,1,2,3] row_mask:0xf bank_mask:0x2
  v_mov_b32_dpp v42, v19 row_ror:12 row_mask:0xf bank_mask:0x2
  v_mov_b32_dpp v43, v19 row_ror:8 row_mask:0xf bank_mask:0x2
  v_mov_b32_dpp v44, v19 row_ror:8 row_mask:0xf bank_mask:0x4
  v_mov_b32_dpp v45, v19 row_ror:4 row_mask:0xf bank_mask:0x4
  v_mov_b32_dpp v46, v19 quad_perm:[0,1,2,3] row_mask:0xf bank_mask:0x4
  v_mov_b32_dpp v47, v19 row_ror:12 row_mask:0xf bank_mask:0x4
  v_mov_b32_dpp v48, v19 row_ror:12 row_mask:0xf bank_mask:0x8
  v_mov_b32_dpp v49, v19 row_ror:8 row_mask:0xf bank_mask:0x8
  v_mov_b32_dpp v50, v19 row_ror:4 row_mask:0xf bank_mask:0x8
  v_mov_b32_dpp v51, v19 quad_perm:[0,1,2,3] row_mask:0xf bank_mask:0x8
  s_waitcnt vmcnt(3)
  v_perm_b32 v128, v176, v160, s54
  v_perm_b32 v132, v176, v160, s55
  v_perm_b32 v136, v177, v161, s54
  v_perm_b32 v140, v177, v161, s55
  v_perm_b32 v144, v178, v162, s54
  v_perm_b32 v148, v178, v162, s55
  v_perm_b32 v152, v179, v163, s54
  v_perm_b32 v156, v179, v163, s55
  s_waitcnt vmcnt(2)
  v_perm_b32 v129, v180, v164, s54
  v_perm_b32 v133, v180, v164, s55
  v_perm_b32 v137, v181, v165, s54
  v_perm_b32 v141, v181, v165, s55
  v_perm_b32 v145, v182, v166, s54
  v_perm_b32 v149, v182, v166, s55
  v_perm_b32 v153, v183, v167, s54
  v_perm_b32 v157, v183, v167, s55
  s_waitcnt vmcnt(1)
  v_perm_b32 v130, v184, v168, s54
  v_perm_b32 v134, v184, v168, s55
  v_perm_b32 v138, v185, v169, s54
  v_perm_b32 v142, v185, v169, s55
  v_perm_b32 v146, v186, v170, s54
  v_perm_b32 v150, v186, v170, s55
  v_perm_b32 v154, v187, v171, s54
  v_perm_b32 v158, v187, v171, s55
  s_waitcnt vmcnt(0)
  v_perm_b32 v131, v188, v172, s54
  v_perm_b32 v135, v188, v172, s55
  v_perm_b32 v139, v189, v173, s54
  v_mfma_f32_16x16x32_bf16 v[28:31], v[36:39], v[128:131], v[28:31]
  v_perm_b32 v143, v189, v173, s55
  v_mfma_f32_16x16x32_bf16 v[28:31], v[40:43], v[132:135], v[28:31]
  v_perm_b32 v147, v190, v174, s54
  v_mfma_f32_16x16x32_bf16 v[28:31], v[44:47], v[136:139], v[28:31]
  v_perm_b32 v151, v190, v174, s55
  v_mfma_f32_16x16x32_bf16 v[28:31], v[48:51], v[140:143], v[28:31]
  v_perm_b32 v155, v191, v175, s54
  v_mfma_f32_16x16x32_bf16 v[32:35], v[36:39], v[144:147], v[32:35]
  v_perm_b32 v159, v191, v175, s55
  v_mfma_f32_16x16x32_bf16 v[32:35], v[40:43], v[148:151], v[32:35]
  v_mfma_f32_16x16x32_bf16 v[32:35], v[44:47], v[152:155], v[32:35]
  v_mfma_f32_16x16x32_bf16 v[32:35], v[48:51], v[156:159], v[32:35]
  s_nop 1
  ds_write_b128 v4, v[28:31] offset:1472
  s_nop 4
  ds_write_b128 v4, v[32:35] offset:2496
  s_mov_b64 exec, -1
  s_waitcnt lgkmcnt(0)
  s_barrier
  s_lshl_b32 s4, s2, 2
  s_add_u32 s4, s4, s3
  s_lshl_b32 s4, s4, 9
  s_add_u32 s4, s4, 589824
  s_load_dword s16, s[40:41], s4 offset:0
  s_load_dword s17, s[40:41], s4 offset:64
  s_load_dword s18, s[40:41], s4 offset:128
  s_load_dword s19, s[40:41], s4 offset:192
  s_load_dword s20, s[40:41], s4 offset:256
  s_load_dword s21, s[40:41], s4 offset:320
  s_load_dword s22, s[40:41], s4 offset:384
  s_load_dword s23, s[40:41], s4 offset:448
  s_barrier
  s_endpgm
L_helper:
  v_and_b32 v3, 15, v0
  v_lshlrev_b32 v3, 2, v3
  v_mov_b32 v4, 0
  ds_write_b32 v3, v4
  s_waitcnt lgkmcnt(0)
  s_barrier
  s_load_dwordx16 s[16:31], s[0:1], 0
  s_load_dwordx8 s[32:39], s[0:1], 64
  s_load_dwordx2 s[40:41], s[0:1], 96
  s_setprio 3
  s_sub_u32 s3, s3, 4
  s_waitcnt lgkmcnt(0)
  s_cmp_lt_u32 s2, 16
  s_cbranch_scc1 L_meas
L_meas_done:
  s_mov_b32 s44, s16
  s_mov_b32 s45, s17
  s_mov_b32 s46, 8192
  s_mov_b32 s47, 0x20000
  s_mov_b32 s48, s22
  s_mov_b32 s49, s23
  s_mov_b32 s50, 4194304
  s_mov_b32 s51, 0x20000
  s_mov_b32 s52, s40
  s_mov_b32 s53, s41
  s_mov_b32 s54, 268435456
  s_mov_b32 s55, 0x20000
  s_mov_b32 s56, s24
  s_mov_b32 s57, s25
  s_mov_b32 s58, 4194304
  s_mov_b32 s59, 0x20000
  s_mov_b32 s60, s28
  s_mov_b32 s61, s29
  s_mov_b32 s62, 3584
  s_mov_b32 s63, 0x20000
  s_mov_b32 s64, s30
  s_mov_b32 s65, s31
  s_mov_b32 s66, 3584
  s_mov_b32 s67, 0x20000
  s_mov_b32 s68, s32
  s_mov_b32 s69, s33
  s_mov_b32 s70, 3584
  s_mov_b32 s71, 0x20000
  v_lshrrev_b32 v5, 4, v1
  v_and_b32 v6, 7, v1
  v_and_b32 v8, 15, v1
  v_lshrrev_b32 v7, 5, v1
  v_and_b32 v4, 31, v1
  v_lshlrev_b32 v4, 4, v4
  v_lshl_add_u32 v2, v7, 10, v4
  s_lshl_b32 s6, s3, 11
  v_mov_b32 v9, 0
  v_mov_b32 v11, 1
  v_lshrrev_b32 v20, 3, v1
  v_lshlrev_b32 v21, 13, v20
  v_lshl_add_u32 v21, v6, 4, v21
  v_lshlrev_b32 v22, 12, v20
  v_lshl_add_u32 v22, v6, 4, v22
  s_and_b32 s15, s2, 7
  s_lshr_b32 s14, s2, 3
  s_add_u32 s4, s14, 1
  s_and_b32 s4, s4, 7
  s_add_u32 s14, s14, 0
  s_and_b32 s14, s14, 7
  s_lshl_b32 s8, s15, 3
  s_add_u32 s8, s8, s4
  s_lshr_b32 s9, s2, 6
  s_lshl_b32 s4, s9, 2
  s_add_u32 s4, s4, s3
  s_lshl_b32 s4, s4, 18
  s_lshl_b32 s5, s8, 7
  s_add_u32 s72, s4, s5
  s_lshl_b32 s13, s15, 2
  s_add_u32 s13, s13, s9
  s_lshl_b32 s4, s13, 2
  s_add_u32 s4, s4, s3
  s_lshl_b32 s4, s4, 15
  s_lshl_b32 s5, s14, 7
  s_add_u32 s73, s4, s5
  s_lshl_b32 s4, s3, 12
  s_add_u32 s74, s4, 19008
  s_mul_i32 s75, s3, 896
  v_lshlrev_b32 v23, 1, v1
  buffer_load_dwordx4 v[32:35], v2, s[44:47], s6 offen
  buffer_load_dwordx4 v[36:39], v2, s[44:47], s6 offen offset:512
  s_load_dword s42, s[40:41], 0
  s_add_u32 m0, s74, 0
  s_nop 0
  buffer_load_dwordx4 v21, s[48:51], s72 offen nt lds
  s_add_u32 s72, s72, 65536
  s_add_u32 m0, s74, 1024
  s_nop 0
  buffer_load_dwordx4 v21, s[48:51], s72 offen nt lds
  s_add_u32 s72, s72, 65536
  s_add_u32 m0, s74, 2048
  s_nop 0
  buffer_load_dwordx4 v21, s[48:51], s72 offen nt lds
  s_add_u32 s72, s72, 65536
  s_add_u32 m0, s74, 3072
  s_nop 0
  buffer_load_dwordx4 v21, s[48:51], s72 offen nt lds
  v_and_b32 v90, 1, v5
  v_lshlrev_b32 v90, 5, v90
  v_xor_b32 v90, v90, v22
  v_xor_b32 v152, 64, v90
  s_mov_b32 s22, s73
  s_mov_b32 s23, s74
  buffer_load_ushort v40, v23, s[60:63], s75 offen offset:0
  buffer_load_ushort v47, v23, s[64:67], s75 offen offset:0
  buffer_load_ushort v54, v23, s[68:71], s75 offen offset:0
  buffer_load_ushort v41, v23, s[60:63], s75 offen offset:128
  buffer_load_ushort v48, v23, s[64:67], s75 offen offset:128
  buffer_load_ushort v55, v23, s[68:71], s75 offen offset:128
  buffer_load_ushort v42, v23, s[60:63], s75 offen offset:256
  buffer_load_ushort v49, v23, s[64:67], s75 offen offset:256
  buffer_load_ushort v56, v23, s[68:71], s75 offen offset:256
  buffer_load_ushort v43, v23, s[60:63], s75 offen offset:384
  buffer_load_ushort v50, v23, s[64:67], s75 offen offset:384
  buffer_load_ushort v57, v23, s[68:71], s75 offen offset:384
  buffer_load_ushort v44, v23, s[60:63], s75 offen offset:512
  buffer_load_ushort v51, v23, s[64:67], s75 offen offset:512
  buffer_load_ushort v58, v23, s[68:71], s75 offen offset:512
  buffer_load_ushort v45, v23, s[60:63], s75 offen offset:640
  buffer_load_ushort v52, v23, s[64:67], s75 offen offset:640
  buffer_load_ushort v59, v23, s[68:71], s75 offen offset:640
  buffer_load_ushort v46, v23, s[60:63], s75 offen offset:768
  buffer_load_ushort v53, v23, s[64:67], s75 offen offset:768
  buffer_load_ushort v60, v23, s[68:71], s75 offen offset:768
  s_mov_b32 s60, s34
  s_mov_b32 s61, s35
  s_mov_b32 s62, 2
  s_mov_b32 s63, 0x20000
  s_mov_b32 s64, s36
  s_mov_b32 s65, s37
  s_mov_b32 s66, 8192
  s_mov_b32 s67, 0x20000
  s_mov_b32 s68, s24
  s_mov_b32 s69, s25
  s_mov_b32 s70, 4194304
  s_mov_b32 s71, 0x20000
  v_and_b32 v30, 3, v1
  v_lshlrev_b32 v30, 1, v30
  v_lshl_add_u32 v30, v5, 5, v30
  s_lshr_b32 s10, s2, 5
  s_lshl3_add_u32 s10, s10, s15
  s_lshl_b32 s10, s10, 7
  s_and_b32 s4, s2, 24
  s_add_u32 s10, s10, s4
  buffer_load_ushort v31, v9, s[60:63], 0 offen
  buffer_load_ushort v29, v30, s[44:47], s10 offen
  s_mov_b32 s16, 0x07060500
  s_mov_b32 s17, 0x07060501
  s_mov_b32 s18, 0x07060502
  s_mov_b32 s19, 0x07060503
  s_mov_b32 s20, 0x0c0c0400
  s_mov_b32 s21, 0x04000c0c
  s_getreg_b32 s43, hwreg(HW_REG_XCC_ID, 0, 4)
  s_lshl_b32 s43, s43, 3
  s_add_u32 s43, s43, s15
  s_lshl_b32 s43, s43, 7
  s_add_u32 s43, s43, 32768
  s_lshr_b32 s59, s2, 3
  s_lshl_b32 s59, s59, 2
  s_add_u32 s59, s59, s43
  s_mov_b32 s11, 0x3f803f80
  v_mov_b32 v12, 0
  v_mov_b32 v13, 0
  s_waitcnt lgkmcnt(0)
  s_add_u32 s42, s42, 1
  s_mul_i32 s12, s42, 0x01010101
  v_mov_b32 v10, s12
  s_and_b32 s25, s12, 0x7f7f7f00
  s_lshl_b32 s25, s25, 1
  s_and_b32 s24, s42, 0xfe
  s_xor_b32 s24, s24, 0x80
  s_or_b32 s25, s25, s24
  v_mov_b32 v151, s25
  s_cmp_eq_u32 s3, 0
  s_cselect_b64 exec, 1, 0
  buffer_store_dword v10, v9, s[52:55], s59 offen
  s_mov_b64 exec, -1
  s_waitcnt vmcnt(28)
  v_dot2_f32_bf16 v12, v32, s11, v12
  v_dot2_f32_bf16 v13, v32, v32, v13
  v_dot2_f32_bf16 v12, v33, s11, v12
  v_dot2_f32_bf16 v13, v33, v33, v13
  v_dot2_f32_bf16 v12, v34, s11, v12
  v_dot2_f32_bf16 v13, v34, v34, v13
  v_dot2_f32_bf16 v12, v35, s11, v12
  v_dot2_f32_bf16 v13, v35, v35, v13
  v_dot2_f32_bf16 v12, v36, s11, v12
  v_dot2_f32_bf16 v13, v36, v36, v13
  v_dot2_f32_bf16 v12, v37, s11, v12
  v_dot2_f32_bf16 v13, v37, v37, v13
  v_dot2_f32_bf16 v12, v38, s11, v12
  v_dot2_f32_bf16 v13, v38, v38, v13
  v_dot2_f32_bf16 v12, v39, s11, v12
  v_dot2_f32_bf16 v13, v39, v39, v13
  s_nop 1
  v_add_f32_dpp v12, v12, v12 row_ror:8 row_mask:0xf bank_mask:0xf
  v_add_f32_dpp v13, v13, v13 row_ror:8 row_mask:0xf bank_mask:0xf
  s_nop 0
  v_add_f32_dpp v12, v12, v12 row_ror:4 row_mask:0xf bank_mask:0xf
  v_add_f32_dpp v13, v13, v13 row_ror:4 row_mask:0xf bank_mask:0xf
  s_nop 0
  v_add_f32_dpp v12, v12, v12 row_ror:2 row_mask:0xf bank_mask:0xf
  v_add_f32_dpp v13, v13, v13 row_ror:2 row_mask:0xf bank_mask:0xf
  s_nop 0
  v_add_f32_dpp v12, v12, v12 row_ror:1 row_mask:0xf bank_mask:0xf
  v_add_f32_dpp v13, v13, v13 row_ror:1 row_mask:0xf bank_mask:0xf
  v_mov_b32 v14, v12
  v_mov_b32 v15, v13
  s_nop 0
  v_permlane16_swap_b32 v12, v14
  v_permlane16_swap_b32 v13, v15
  v_add_f32 v12, v12, v14
  v_add_f32 v13, v13, v15
  v_mul_f32 v12, 0x3b000000, v12
  v_mul_f32 v13, 0x3b000000, v13
  v_fma_f32 v13, -v12, v12, v13
  v_max_f32 v13, 0, v13
  v_cvt_pk_bf16_f32 v12, v12, v12
  v_lshlrev_b32 v12, 16, v12
  v_cvt_pk_bf16_f32 v13, v13, v13
  v_lshlrev_b32 v13, 16, v13
  v_add_f32 v13, 0x3727c5ac, v13
  v_cvt_pk_bf16_f32 v13, v13, v13
  v_lshlrev_b32 v13, 16, v13
  v_sqrt_f32 v13, v13
  s_nop 0
  v_cvt_pk_bf16_f32 v13, v13, v13
  v_lshlrev_b32 v13, 16, v13
  v_rcp_f32 v18, v13
  v_sub_f32 v16, 0, v12
  v_sub_f32 v17, 0, v12
  v_mov_b32 v19, v18
  v_lshlrev_b32 v20, 16, v32
  v_and_b32 v21, 0xffff0000, v32
  v_lshlrev_b32 v22, 16, v33
  v_and_b32 v23, 0xffff0000, v33
  v_lshlrev_b32 v24, 16, v34
  v_and_b32 v25, 0xffff0000, v34
  v_lshlrev_b32 v26, 16, v35
  v_and_b32 v27, 0xffff0000, v35
  v_pk_add_f32 v[20:21], v[20:21], v[16:17]
  v_pk_add_f32 v[22:23], v[22:23], v[16:17]
  v_pk_add_f32 v[24:25], v[24:25], v[16:17]
  v_pk_add_f32 v[26:27], v[26:27], v[16:17]
  v_cvt_pk_bf16_f32 v20, v20, v21
  v_cvt_pk_bf16_f32 v22, v22, v23
  v_cvt_pk_bf16_f32 v24, v24, v25
  v_cvt_pk_bf16_f32 v26, v26, v27
  v_and_b32 v21, 0xffff0000, v20
  v_lshlrev_b32 v20, 16, v20
  v_and_b32 v23, 0xffff0000, v22
  v_lshlrev_b32 v22, 16, v22
  v_and_b32 v25, 0xffff0000, v24
  v_lshlrev_b32 v24, 16, v24
  v_and_b32 v27, 0xffff0000, v26
  v_lshlrev_b32 v26, 16, v26
  v_pk_mul_f32 v[20:21], v[20:21], v[18:19]
  v_pk_mul_f32 v[22:23], v[22:23], v[18:19]
  v_pk_mul_f32 v[24:25], v[24:25], v[18:19]
  v_pk_mul_f32 v[26:27], v[26:27], v[18:19]
  v_cvt_pk_bf16_f32 v32, v20, v21
  v_cvt_pk_bf16_f32 v33, v22, v23
  v_cvt_pk_bf16_f32 v34, v24, v25
  v_cvt_pk_bf16_f32 v35, v26, v27
  v_lshlrev_b32 v20, 16, v36
  v_and_b32 v21, 0xffff0000, v36
  v_lshlrev_b32 v22, 16, v37
  v_and_b32 v23, 0xffff0000, v37
  v_lshlrev_b32 v24, 16, v38
  v_and_b32 v25, 0xffff0000, v38
  v_lshlrev_b32 v26, 16, v39
  v_and_b32 v27, 0xffff0000, v39
  v_pk_add_f32 v[20:21], v[20:21], v[16:17]
  v_pk_add_f32 v[22:23], v[22:23], v[16:17]
  v_pk_add_f32 v[24:25], v[24:25], v[16:17]
  v_pk_add_f32 v[26:27], v[26:27], v[16:17]
  v_cvt_pk_bf16_f32 v20, v20, v21
  v_cvt_pk_bf16_f32 v22, v22, v23
  v_cvt_pk_bf16_f32 v24, v24, v25
  v_cvt_pk_bf16_f32 v26, v26, v27
  v_and_b32 v21, 0xffff0000, v20
  v_lshlrev_b32 v20, 16, v20
  v_and_b32 v23, 0xffff0000, v22
  v_lshlrev_b32 v22, 16, v22
  v_and_b32 v25, 0xffff0000, v24
  v_lshlrev_b32 v24, 16, v24
  v_and_b32 v27, 0xffff0000, v26
  v_lshlrev_b32 v26, 16, v26
  v_pk_mul_f32 v[20:21], v[20:21], v[18:19]
  v_pk_mul_f32 v[22:23], v[22:23], v[18:19]
  v_pk_mul_f32 v[24:25], v[24:25], v[18:19]
  v_pk_mul_f32 v[26:27], v[26:27], v[18:19]
  v_cvt_pk_bf16_f32 v36, v20, v21
  v_cvt_pk_bf16_f32 v37, v22, v23
  v_cvt_pk_bf16_f32 v38, v24, v25
  v_cvt_pk_bf16_f32 v39, v26, v27
  s_mul_i32 s4, s3, 2080
  v_mul_u32_u24 v2, 1040, v7
  v_add3_u32 v2, v2, v4, s4
  ds_write_b128 v2, v[32:35] offset:10688
  ds_write_b128 v2, v[36:39] offset:11200
  v_mul_u32_u24 v2, 1040, v6
  v_lshl_add_u32 v2, v5, 4, v2
  s_lshl_b32 s4, s9, 8
  v_add_u32 v2, s4, v2
  v_bfe_u32 v3, v1, 2, 2
  v_lshl_add_u32 v3, v5, 3, v3
  v_lshlrev_b32 v3, 7, v3
  v_and_b32 v20, 3, v1
  v_lshl_add_u32 v3, v20, 3, v3
  s_lshl_b32 s4, s3, 5
  v_add_u32 v24, s4, v3
  s_waitcnt vmcnt(24) lgkmcnt(0)
  s_mov_b64 exec, 1
  ds_add_u32 v9, v11 offset:8
  s_mov_b64 exec, -1
  v_and_b32 v27, 31, v1
  v_lshlrev_b32 v27, 2, v27
  buffer_load_dword v150, v27, s[52:55], s43 offen nt
  v_lshlrev_b32 v25, 4, v5
  v_lshl_add_u32 v25, v6, 11, v25
  s_lshr_b32 s4, s8, 1
  s_lshl_b32 s4, s4, 5
  s_add_u32 s4, s4, s9
  s_lshl_b32 s4, s4, 1
  s_and_b32 s5, s8, 1
  s_add_u32 s4, s4, s5
  s_lshl_b32 s4, s4, 2
  s_add_u32 s4, s4, s3
  s_lshl_b32 s4, s4, 6
  s_add_u32 s72, s4, 65536
  s_mov_b32 s26, 0
  s_mov_b32 s58, 3200000
L_xw:
  ds_read_b32 v4, v9 offset:8
  s_waitcnt lgkmcnt(0)
  v_readfirstlane_b32 s59, v4
  s_sub_u32 s58, s58, 1
  s_cbranch_scc1 L_xw_done
  s_cmp_lt_u32 s59, 4
  s_cbranch_scc1 L_xw
L_xw_done:
  ds_read_b128 v[96:99], v2 offset:10688
  ds_read_b64_tr_b16 v[112:113], v24 offset:19008
  ds_read_b64_tr_b16 v[114:115], v24 offset:19520
  ds_read_b128 v[100:103], v2 offset:10752
  ds_read_b64_tr_b16 v[116:117], v24 offset:23104
  ds_read_b64_tr_b16 v[118:119], v24 offset:23616
  ds_read_b128 v[104:107], v2 offset:10816
  ds_read_b64_tr_b16 v[120:121], v24 offset:27200
  ds_read_b64_tr_b16 v[122:123], v24 offset:27712
  ds_read_b128 v[108:111], v2 offset:10880
  ds_read_b64_tr_b16 v[124:125], v24 offset:31296
  ds_read_b64_tr_b16 v[126:127], v24 offset:31808
  s_waitcnt lgkmcnt(0)
  v_mfma_f32_16x16x32_bf16 v[128:131], v[112:115], v[96:99], 0
  v_mfma_f32_16x16x32_bf16 v[128:131], v[116:119], v[100:103], v[128:131]
  v_mfma_f32_16x16x32_bf16 v[128:131], v[120:123], v[104:107], v[128:131]
  v_mfma_f32_16x16x32_bf16 v[128:131], v[124:127], v[108:111], v[128:131]
  s_nop 7
  v_add_u32 v128, 0x80, v128
  v_add_u32 v129, 0x80, v129
  v_add_u32 v130, 0x80, v130
  v_add_u32 v131, 0x80, v131
  v_perm_b32 v132, v128, v151, s16
  v_perm_b32 v133, v129, v151, s17
  v_perm_b32 v134, v130, v151, s18
  v_perm_b32 v135, v131, v151, s19
  s_movk_i32 s58, 200
L_lc:
  s_waitcnt vmcnt(0)
  v_cmp_ne_u32 vcc, s12, v150
  s_nop 0
  s_cbranch_vccz L_lc_done
  buffer_load_dword v150, v27, s[52:55], s43 offen nt
  s_sub_u32 s58, s58, 1
  s_cbranch_scc0 L_lc
  s_mov_b32 s26, 1
L_lc_done:
  s_mov_b32 exec_lo, 0x00ff00ff
  s_mov_b32 exec_hi, 0x00ff00ff
  s_cmp_lg_u32 s26, 0
  s_cbranch_scc1 L_qs_far
  buffer_store_dwordx4 v[132:135], v25, s[52:55], s72 offen
L_qs_done:
  s_mov_b64 exec, -1
  s_lshl_b32 s4, s3, 8
  s_add_u32 s4, s4, s2
  s_sub_u32 s4, s4, 512
  s_cmp_lt_u32 s4, 16
  s_cbranch_scc1 L_mpub
L_mpub_done:
  s_setprio 0
  v_bfe_u32 v153, v1, 3, 2
  v_lshl_add_u32 v153, v153, 5, v3
  v_xor_b32 v154, 32, v153
  v_xor_b32 v155, 64, v153
  v_xor_b32 v156, 0x60, v153
  s_lshr_b32 s4, s2, 5
  s_mul_i32 s4, s4, 1040
  v_lshl_add_u32 v2, v1, 4, s4
  ds_read_b128 v[62:65], v2 offset:10688
  v_mov_b32 v12, 0
  v_mov_b32 v13, 0
  s_waitcnt lgkmcnt(0)
  v_dot2_f32_bf16 v12, v62, s11, v12
  v_dot2_f32_bf16 v13, v62, v62, v13
  v_dot2_f32_bf16 v12, v63, s11, v12
  v_dot2_f32_bf16 v13, v63, v63, v13
  v_dot2_f32_bf16 v12, v64, s11, v12
  v_dot2_f32_bf16 v13, v64, v64, v13
  v_dot2_f32_bf16 v12, v65, s11, v12
  v_dot2_f32_bf16 v13, v65, v65, v13
  s_nop 1
  v_add_f32_dpp v12, v12, v12 row_ror:8 row_mask:0xf bank_mask:0xf
  v_add_f32_dpp v13, v13, v13 row_ror:8 row_mask:0xf bank_mask:0xf
  s_nop 0
  v_add_f32_dpp v12, v12, v12 row_ror:4 row_mask:0xf bank_mask:0xf
  v_add_f32_dpp v13, v13, v13 row_ror:4 row_mask:0xf bank_mask:0xf
  s_nop 0
  v_add_f32_dpp v12, v12, v12 row_ror:2 row_mask:0xf bank_mask:0xf
  v_add_f32_dpp v13, v13, v13 row_ror:2 row_mask:0xf bank_mask:0xf
  s_nop 0
  v_add_f32_dpp v12, v12, v12 row_ror:1 row_mask:0xf bank_mask:0xf
  v_add_f32_dpp v13, v13, v13 row_ror:1 row_mask:0xf bank_mask:0xf
  v_mov_b32 v14, v12
  s_nop 1
  v_permlane16_swap_b32 v12, v14
  v_add_f32 v12, v12, v14
  v_mov_b32 v14, v12
  s_nop 1
  v_permlane32_swap_b32 v12, v14
  v_add_f32 v12, v12, v14
  v_mov_b32 v15, v13
  s_nop 1
  v_permlane16_swap_b32 v13, v15
  v_add_f32 v13, v13, v15
  v_mov_b32 v15, v13
  s_nop 1
  v_permlane32_swap_b32 v13, v15
  v_add_f32 v13, v13, v15
  v_mul_f32 v12, 0x3b000000, v12
  v_mul_f32 v13, 0x3b000000, v13
  v_fma_f32 v13, -v12, v12, v13
  v_max_f32 v13, 0, v13
  v_cvt_pk_bf16_f32 v12, v12, v12
  v_lshlrev_b32 v12, 16, v12
  v_cvt_pk_bf16_f32 v13, v13, v13
  v_lshlrev_b32 v13, 16, v13
  v_add_f32 v13, 0x3727c5ac, v13
  v_cvt_pk_bf16_f32 v13, v13, v13
  v_lshlrev_b32 v13, 16, v13
  v_sqrt_f32 v13, v13
  s_nop 0
  v_cvt_pk_bf16_f32 v13, v13, v13
  v_lshlrev_b32 v13, 16, v13
  v_rcp_f32 v18, v13
  v_sub_f32 v16, 0, v12
  v_sub_f32 v17, 0, v12
  v_mov_b32 v19, v18
  v_lshlrev_b32 v20, 16, v62
  v_and_b32 v21, 0xffff0000, v62
  v_lshlrev_b32 v22, 16, v63
  v_and_b32 v23, 0xffff0000, v63
  v_lshlrev_b32 v24, 16, v64
  v_and_b32 v25, 0xffff0000, v64
  v_lshlrev_b32 v26, 16, v65
  v_and_b32 v27, 0xffff0000, v65
  v_pk_add_f32 v[20:21], v[20:21], v[16:17]
  v_pk_add_f32 v[22:23], v[22:23], v[16:17]
  v_pk_add_f32 v[24:25], v[24:25], v[16:17]
  v_pk_add_f32 v[26:27], v[26:27], v[16:17]
  v_cvt_pk_bf16_f32 v20, v20, v21
  v_cvt_pk_bf16_f32 v22, v22, v23
  v_cvt_pk_bf16_f32 v24, v24, v25
  v_cvt_pk_bf16_f32 v26, v26, v27
  v_and_b32 v21, 0xffff0000, v20
  v_lshlrev_b32 v20, 16, v20
  v_and_b32 v23, 0xffff0000, v22
  v_lshlrev_b32 v22, 16, v22
  v_and_b32 v25, 0xffff0000, v24
  v_lshlrev_b32 v24, 16, v24
  v_and_b32 v27, 0xffff0000, v26
  v_lshlrev_b32 v26, 16, v26
  v_pk_mul_f32 v[20:21], v[20:21], v[18:19]
  v_pk_mul_f32 v[22:23], v[22:23], v[18:19]
  v_pk_mul_f32 v[24:25], v[24:25], v[18:19]
  v_pk_mul_f32 v[26:27], v[26:27], v[18:19]
  v_cvt_pk_bf16_f32 v62, v20, v21
  v_cvt_pk_bf16_f32 v63, v22, v23
  v_cvt_pk_bf16_f32 v64, v24, v25
  v_cvt_pk_bf16_f32 v65, v26, v27
  s_bitcmp1_b32 s2, 3
  s_cselect_b64 vcc, -1, 0
  s_bfe_u32 s4, s2, 0x30000
  s_lshl_b32 s4, s4, 3
  s_bfe_u32 s5, s2, 0x10004
  s_add_u32 s4, s4, s5
  v_cndmask_b32 v62, v62, v64, vcc
  v_cndmask_b32 v63, v63, v65, vcc
  v_readlane_b32 s72, v62, s4
  v_readlane_b32 s73, v63, s4
  s_add_u32 s4, s4, 2
  v_readlane_b32 s74, v62, s4
  v_readlane_b32 s75, v63, s4
  s_add_u32 s4, s4, 2
  v_readlane_b32 s76, v62, s4
  v_readlane_b32 s77, v63, s4
  s_add_u32 s4, s4, 2
  v_readlane_b32 s78, v62, s4
  v_readlane_b32 s79, v63, s4
  s_waitcnt vmcnt(2)
  v_lshlrev_b32 v40, 16, v40
  v_lshlrev_b32 v41, 16, v41
  v_lshlrev_b32 v42, 16, v42
  v_lshlrev_b32 v43, 16, v43
  v_lshlrev_b32 v44, 16, v44
  v_lshlrev_b32 v45, 16, v45
  v_lshlrev_b32 v46, 16, v46
  v_lshlrev_b32 v47, 16, v47
  v_lshlrev_b32 v48, 16, v48
  v_lshlrev_b32 v49, 16, v49
  v_lshlrev_b32 v50, 16, v50
  v_lshlrev_b32 v51, 16, v51
  v_lshlrev_b32 v52, 16, v52
  v_lshlrev_b32 v53, 16, v53
  v_lshlrev_b32 v54, 16, v54
  v_lshlrev_b32 v55, 16, v55
  v_lshlrev_b32 v56, 16, v56
  v_lshlrev_b32 v57, 16, v57
  v_lshlrev_b32 v58, 16, v58
  v_lshlrev_b32 v59, 16, v59
  v_lshlrev_b32 v60, 16, v60
  v_mov_b32 v88, 0xbdd2d3e8
  s_lshl_b32 s4, s3, 6
  v_mov_b32 v89, s4
  s_lshl_b32 s4, s72, 16
  s_call_b64 s[80:81], L_mlp
  s_and_b32 s4, s72, 0xffff0000
  s_call_b64 s[80:81], L_mlp
  s_setprio 3
  s_lshr_b32 s4, s2, 5
  s_lshl_b32 s4, s4, 11
  s_lshl_b32 s5, s15, 2
  s_add_u32 s5, s5, s3
  s_lshl_b32 s5, s5, 14
  s_add_u32 s4, s4, s5
  s_add_u32 s6, s4, 65536
  v_lshlrev_b32 v2, 4, v1
  s_cmp_lg_u32 s26, 0
  s_cbranch_scc1 L_gq_far
  s_mov_b32 s58, 400000
L_gq:
  buffer_load_dwordx4 v[96:99], v2, s[52:55], s6 offen offset:0 nt
  buffer_load_dwordx4 v[100:103], v2, s[52:55], s6 offen offset:1024 nt
  s_waitcnt vmcnt(0)
  v_perm_b32 v104, v97, v96, s20
  v_perm_b32 v105, v99, v98, s21
  v_perm_b32 v106, v101, v100, s20
  v_perm_b32 v107, v103, v102, s21
  v_bitop3_b32 v104, v104, v105, s25 bitop3:0x56
  v_bitop3_b32 v106, v106, v107, s25 bitop3:0x56
  v_or_b32 v104, v104, v106
  v_cmp_ne_u32 vcc, 0, v104
  s_nop 0
  s_cbranch_vccz L_gq_done
  s_sub_u32 s58, s58, 1
  s_cbranch_scc1 L_gq_done
  s_and_b64 exec, exec, vcc
  s_branch L_gq
L_gq_done:
  s_mov_b64 exec, -1
L_gq_got:
  v_and_b32 v96, 0xffffff00, v96
  v_and_b32 v97, 0xffffff00, v97
  v_and_b32 v98, 0xffffff00, v98
  v_and_b32 v99, 0xffffff00, v99
  v_and_b32 v100, 0xffffff00, v100
  v_and_b32 v101, 0xffffff00, v101
  v_and_b32 v102, 0xffffff00, v102
  v_and_b32 v103, 0xffffff00, v103
  v_add_f32 v96, v96, v100
  v_add_f32 v97, v97, v101
  v_add_f32 v98, v98, v102
  v_add_f32 v99, v99, v103
  s_lshl_b32 s4, s3, 8
  v_and_b32 v2, 31, v1
  v_lshl_add_u32 v2, v2, 3, s4
  v_lshl_add_u32 v2, v7, 2, v2
  v_permlane32_swap_b32 v96, v98
  v_permlane32_swap_b32 v97, v99
  v_add_f32 v96, v96, v98
  v_add_f32 v97, v97, v99
  v_cvt_pk_bf16_f32 v96, v96, v97
  ds_write_b32 v2, v96 offset:64
  s_waitcnt lgkmcnt(0)
  s_mov_b64 exec, 1
  ds_add_u32 v9, v11 offset:4
  s_mov_b64 exec, -1
  s_setprio 0
  s_lshl_b32 s4, s73, 16
  s_call_b64 s[80:81], L_mlp
  s_and_b32 s4, s73, 0xffff0000
  s_call_b64 s[80:81], L_mlp
  s_lshl_b32 s4, s74, 16
  s_call_b64 s[80:81], L_mlp
  s_and_b32 s4, s74, 0xffff0000
  s_call_b64 s[80:81], L_mlp
  s_lshl_b32 s4, s75, 16
  s_call_b64 s[80:81], L_mlp
  s_and_b32 s4, s75, 0xffff0000
  s_call_b64 s[80:81], L_mlp
  s_lshl_b32 s4, s76, 16
  s_call_b64 s[80:81], L_mlp
  s_and_b32 s4, s76, 0xffff0000
  s_call_b64 s[80:81], L_mlp
  s_lshl_b32 s4, s77, 16
  s_call_b64 s[80:81], L_mlp
  s_and_b32 s4, s77, 0xffff0000
  s_call_b64 s[80:81], L_mlp
  s_lshl_b32 s4, s78, 16
  s_call_b64 s[80:81], L_mlp
  s_and_b32 s4, s78, 0xffff0000
  s_call_b64 s[80:81], L_mlp
  s_lshl_b32 s4, s79, 16
  s_call_b64 s[80:81], L_mlp
  s_and_b32 s4, s79, 0xffff0000
  s_call_b64 s[80:81], L_mlp
  s_waitcnt vmcnt(0) lgkmcnt(0)
  s_mov_b64 exec, 1
  ds_add_u32 v9, v11 offset:12
  s_mov_b64 exec, -1
  v_lshrrev_b32 v2, 2, v1
  v_mul_u32_u24 v20, 144, v2
  v_and_b32 v3, 3, v1
  v_lshl_add_u32 v20, v3, 5, v20
  s_lshl_b32 s4, s3, 2
  s_add_u32 s4, s4, 1472
  v_add_u32 v20, s4, v20
  v_add_u32 v21, 2304, v20
  v_add_u32 v22, 4608, v20
  v_add_u32 v23, 6912, v20
  s_lshl_b32 s4, s3, 3
  v_mov_b32 v24, s4
  v_lshrrev_b32 v25, 5, v1
  v_lshlrev_b32 v25, 7, v25
  v_bfe_u32 v2, v1, 4, 1
  v_lshl_add_u32 v25, v2, 11, v25
  v_bfe_u32 v2, v1, 1, 1
  v_lshl_add_u32 v25, v2, 10, v25
  v_bfe_u32 v2, v1, 2, 2
  v_lshl_add_u32 v25, v2, 8, v25
  v_and_b32 v2, 1, v1
  v_lshl_add_u32 v25, v2, 3, v25
  v_lshlrev_b32 v26, 4, v1
  v_and_b32 v2, 1, v5
  v_lshl_add_u32 v27, v2, 2, v3
  v_lshlrev_b32 v27, 4, v27
  v_lshlrev_b32 v28, 16, v2
  v_bfe_u32 v2, v1, 2, 2
  v_lshl_add_u32 v28, v2, 11, v28
  v_lshl_add_u32 v28, v3, 4, v28
  v_lshrrev_b32 v19, 2, v1
  v_lshlrev_b32 v19, 6, v19
  v_lshl_add_u32 v19, v3, 4, v19
  s_lshl_b32 s4, s15, 2
  s_add_u32 s4, s4, s3
  s_lshl_b32 s4, s4, 2
  s_add_u32 s4, s4, s9
  s_mul_i32 s4, s4, 4224
  s_bfe_u32 s5, s2, 0x30003
  s_lshl_b32 s5, s5, 4
  s_add_u32 s4, s4, s5
  s_add_u32 s6, s4, 1114112
  s_lshl_b32 s4, s13, 2
  s_add_u32 s4, s4, s3
  s_mul_i32 s4, s4, 4224
  s_add_u32 s7, s4, 1114112
  s_lshl_b32 s4, s3, 6
  s_lshl_b32 s5, s14, 0
  s_add_u32 s4, s4, s5
  s_lshl_b32 s4, s4, 11
  s_lshl_b32 s5, s13, 6
  s_add_u32 s4, s4, s5
  s_add_u32 s8, s4, 589824
  v_lshlrev_b32 v20, 4, v8
  v_lshl_add_u32 v20, v5, 2, v20
  s_lshl_b32 s4, s3, 8
  s_add_u32 s4, s4, 1472
  v_add_u32 v20, s4, v20
  v_lshlrev_b32 v24, 3, v5
  v_mul_u32_u24 v25, 16384, v5
  v_lshl_add_u32 v25, v8, 3, v25
  s_lshl_b32 s4, s15, 4
  s_add_u32 s4, s4, s9
  s_mul_i32 s4, s4, 4096
  s_bfe_u32 s5, s2, 0x30003
  s_lshl_b32 s5, s5, 9
  s_add_u32 s4, s4, s5
  s_lshl_b32 s5, s3, 7
  s_add_u32 s4, s4, s5
  s_add_u32 s28, s4, 65408
  s_lshl_b32 s30, s13, 2
  s_add_u32 s30, s30, s3
  s_lshl_b32 s30, s30, 12
  s_add_u32 s30, s30, 65408
  v_bfe_u32 v2, v1, 3, 1
  v_lshlrev_b32 v26, 11, v2
  v_lshl_add_u32 v26, v5, 7, v26
  v_lshl_add_u32 v26, v6, 4, v26
  v_lshl_add_u32 v27, v2, 2, v3
  v_lshlrev_b32 v27, 4, v27
  v_lshlrev_b32 v28, 16, v7
  v_bfe_u32 v2, v1, 2, 2
  v_lshl_add_u32 v28, v2, 14, v28
  v_lshl_add_u32 v28, v3, 4, v28
  s_lshl_b32 s29, s3, 4
  s_lshl_b32 s4, s3, 1
  v_add_u32 v2, s4, v6
  v_and_b32 v2, 7, v2
  v_and_b32 v26, 0xffffff8f, v26
  v_lshl_add_u32 v26, v2, 4, v26
  s_add_u32 s4, s3, 0
  s_and_b32 s4, s4, 3
  s_lshl_b32 s4, s4, 12
  v_add_u32 v176, s4, v153
  v_add_u32 v177, s4, v154
  v_add_u32 v178, s4, v155
  v_add_u32 v179, s4, v156
  s_add_u32 s4, s3, 1
  s_and_b32 s4, s4, 3
  s_lshl_b32 s4, s4, 12
  v_add_u32 v180, s4, v153
  v_add_u32 v181, s4, v154
  v_add_u32 v182, s4, v155
  v_add_u32 v183, s4, v156
  s_add_u32 s4, s3, 2
  s_and_b32 s4, s4, 3
  s_lshl_b32 s4, s4, 12
  v_add_u32 v184, s4, v153
  v_add_u32 v185, s4, v154
  v_add_u32 v186, s4, v155
  v_add_u32 v187, s4, v156
  s_add_u32 s4, s3, 3
  s_and_b32 s4, s4, 3
  s_lshl_b32 s4, s4, 12
  v_add_u32 v188, s4, v153
  v_add_u32 v189, s4, v154
  v_add_u32 v190, s4, v155
  v_add_u32 v191, s4, v156
  s_lshl_b32 s9, s2, 11
  s_add_u32 s9, s9, 589824
  s_mov_b32 s5, 16384
  v_and_b32 v2, 15, v1
  v_lshlrev_b32 v2, 3, v2
  s_mov_b32 s58, 400000
L_cwp:
  buffer_load_dwordx2 v[94:95], v2, s[52:55], s5 offen sc1
  s_waitcnt vmcnt(0)
  v_xor_b32 v80, s12, v95
  v_cmp_ne_u32 vcc, 0, v80
  s_nop 0
  s_cbranch_vccz L_cwp_done
  s_sub_u32 s58, s58, 1
  s_cbranch_scc1 L_cwp_done
  s_and_b64 exec, exec, vcc
  s_sleep 4
  s_branch L_cwp
L_cwp_done:
  s_mov_b64 exec, -1
  v_sub_u32 v95, 0, v94
  v_cmp_gt_u32 vcc, 4, v6
  s_nop 1
  v_cndmask_b32 v94, v95, v94, vcc
  s_nop 1
  v_add_u32_dpp v94, v94, v94 row_ror:8 row_mask:0xf bank_mask:0xf
  s_nop 1
  v_add_u32_dpp v94, v94, v94 row_ror:4 row_mask:0xf bank_mask:0xf
  s_nop 1
  v_add_u32_dpp v94, v94, v94 row_ror:2 row_mask:0xf bank_mask:0xf
  s_nop 1
  v_add_u32_dpp v94, v94, v94 row_ror:1 row_mask:0xf bank_mask:0xf
  s_nop 0
  v_readfirstlane_b32 s4, v94
  s_nop 0
  s_cmp_gt_i32 s4, 0
  s_cselect_b32 s4, 8192, 0
  s_xor_b32 s8, s8, s4
  s_xor_b32 s9, s9, s4
  s_cmp_lg_u32 s3, 0
  s_cbranch_scc1 L_ready
  s_mov_b32 s58, 3200000
L_yw:
  ds_read_b32 v4, v9 offset:12
  s_waitcnt lgkmcnt(0)
  v_readfirstlane_b32 s59, v4
  s_sub_u32 s58, s58, 1
  s_cbranch_scc1 L_yw_done
  s_cmp_lt_u32 s59, 4
  s_cbranch_scc1 L_yw
L_yw_done:
  v_lshl_add_u32 v2, v5, 2, v3
  v_lshlrev_b32 v2, 2, v2
  ds_read_b32 v32, v2 offset:1216
  ds_read_b32 v33, v2 offset:1280
  ds_read_b32 v34, v2 offset:1344
  ds_read_b32 v35, v2 offset:1408
  v_lshlrev_b32 v31, 16, v31
  s_waitcnt lgkmcnt(0)
  v_add_f32 v32, v32, v33
  v_add_f32 v34, v34, v35
  v_add_f32 v32, v32, v34
  v_cvt_pk_bf16_f32 v32, v32, v32
  v_lshlrev_b32 v32, 16, v32
  v_add_f32 v32, v32, v31
  v_cvt_pk_bf16_f32 v32, v32, v32
  v_lshlrev_b32 v32, 16, v32
  v_mul_f32 v34, 0xbfb8aa3b, v32
  v_exp_f32 v34, v34
  s_nop 0
  v_add_f32 v34, 1.0, v34
  v_rcp_f32 v34, v34
  s_nop 0
  v_mul_f32 v32, v32, v34
  v_cvt_pk_bf16_f32 v32, v32, v32
  v_lshlrev_b32 v16, 16, v32
  v_lshlrev_b32 v14, 16, v29
L_ready:
  s_mov_b32 s58, 3200000
L_sw:
  ds_read_b32 v4, v9 offset:16
  s_waitcnt lgkmcnt(0)
  v_readfirstlane_b32 s59, v4
  s_sub_u32 s58, s58, 1
  s_cbranch_scc1 L_sw_done
  s_cmp_lt_u32 s59, 4
  s_sleep 8
  s_cbranch_scc1 L_sw
L_sw_done:
  ds_read_b64 v[32:33], v24 offset:1088
  ds_read_b64 v[34:35], v24 offset:1120
  ds_read_b64 v[36:37], v24 offset:1152
  ds_read_b64 v[38:39], v24 offset:1184
  s_waitcnt lgkmcnt(0)
  v_max3_f32 v48, v32, v34, v36
  v_max_f32 v48, v48, v38
  v_sub_f32 v32, v32, v48
  v_sub_f32 v34, v34, v48
  v_sub_f32 v36, v36, v48
  v_sub_f32 v38, v38, v48
  v_exp_f32 v32, v32
  v_exp_f32 v34, v34
  v_exp_f32 v36, v36
  v_exp_f32 v38, v38
  v_mov_b32 v49, v10
  v_mov_b32 v51, v10
  v_mul_f32 v50, v32, v33
  v_fmac_f32 v50, v34, v35
  v_fmac_f32 v50, v36, v37
  v_fmac_f32 v50, v38, v39
  s_lshl_b64 exec, 1, s29
  s_cmp_lg_u32 s26, 0
  s_cbranch_scc1 L_st_far
  buffer_store_dwordx4 v[48:51], v9, s[52:55], s6 offen
  s_mov_b64 exec, -1
  s_mov_b32 s58, 400000
L_sp:
  buffer_load_dwordx4 v[40:43], v27, s[52:55], s7 offen nt
  s_waitcnt vmcnt(0)
  v_bitop3_b32 v80, v41, v43, s12 bitop3:0x7e
  v_cmp_ne_u32 vcc, 0, v80
  s_nop 0
  s_cbranch_vccz L_sp_done
  s_sub_u32 s58, s58, 1
  s_cbranch_scc1 L_sp_done
  s_and_b64 exec, exec, vcc
  s_sleep 8
  s_branch L_sp
L_sp_done:
  s_mov_b64 exec, -1
  s_branch L_st_done
L_st_far:
  buffer_store_dwordx4 v[48:51], v9, s[52:55], s6 offen sc1
  s_mov_b64 exec, -1
  s_mov_b32 s58, 400000
L_spx:
  buffer_load_dwordx4 v[40:43], v27, s[52:55], s7 offen sc1
  s_waitcnt vmcnt(0)
  v_bitop3_b32 v80, v41, v43, s12 bitop3:0x7e
  v_cmp_ne_u32 vcc, 0, v80
  s_nop 0
  s_cbranch_vccz L_spx_done
  s_sub_u32 s58, s58, 1
  s_cbranch_scc1 L_spx_done
  s_and_b64 exec, exec, vcc
  s_sleep 8
  s_branch L_spx
L_spx_done:
  s_mov_b64 exec, -1
L_st_done:
  v_max_f32_dpp v44, v40, v40 quad_perm:[1,0,3,2] row_mask:0xf bank_mask:0xf
  s_nop 1
  v_max_f32_dpp v45, v44, v44 quad_perm:[2,3,0,1] row_mask:0xf bank_mask:0xf
  v_sub_f32 v40, v40, v45
  v_exp_f32 v40, v40
  s_nop 0
  v_mul_f32 v42, v40, v42
  s_nop 1
  v_add_f32_dpp v44, v42, v42 quad_perm:[1,0,3,2] row_mask:0xf bank_mask:0xf
  s_nop 1
  v_add_f32_dpp v45, v44, v44 quad_perm:[2,3,0,1] row_mask:0xf bank_mask:0xf
  v_rcp_f32 v45, v45
  s_nop 0
  v_mul_f32 v40, v40, v45
  s_nop 1
  v_mov_b32_dpp v56, v40 quad_perm:[0,0,0,0] row_mask:0xf bank_mask:0xf
  v_mov_b32_dpp v57, v40 quad_perm:[1,1,1,1] row_mask:0xf bank_mask:0xf
  v_mov_b32_dpp v58, v40 quad_perm:[2,2,2,2] row_mask:0xf bank_mask:0xf
  v_mov_b32_dpp v59, v40 quad_perm:[3,3,3,3] row_mask:0xf bank_mask:0xf
L_pre2:
  s_setprio 3
  s_waitcnt vmcnt(0) lgkmcnt(0)
  s_mov_b32 s58, 3200000
L_wt:
  ds_read_b32 v4, v9 offset:28
  s_waitcnt lgkmcnt(0)
  v_readfirstlane_b32 s59, v4
  s_sub_u32 s58, s58, 1
  s_cbranch_scc1 L_wt_done
  s_cmp_lt_u32 s59, 1
  s_sleep 1
  s_cbranch_scc1 L_wt
L_wt_done:
  s_add_u32 m0, s23, 16384
  s_nop 0
  buffer_load_dwordx4 v90, s[68:71], s22 offen nt lds
  s_add_u32 s22, s22, 1024
  s_add_u32 m0, s23, 17408
  s_nop 0
  buffer_load_dwordx4 v152, s[68:71], s22 offen nt lds
  s_add_u32 s22, s22, 1024
  s_add_u32 m0, s23, 18432
  s_nop 0
  buffer_load_dwordx4 v90, s[68:71], s22 offen nt lds
  s_add_u32 s22, s22, 1024
  s_add_u32 m0, s23, 19456
  s_nop 0
  buffer_load_dwordx4 v152, s[68:71], s22 offen nt lds
  s_barrier
  ds_read2st64_b32 v[40:41], v20 offset0:0 offset1:4
  ds_read2st64_b32 v[42:43], v20 offset0:8 offset1:12
  ds_read2st64_b32 v[44:45], v20 offset0:16 offset1:20
  ds_read2st64_b32 v[46:47], v20 offset0:24 offset1:28
  s_waitcnt lgkmcnt(3)
  v_pk_mul_f32 v[40:41], v[40:41], v[32:33] op_sel_hi:[1,0]
  s_waitcnt lgkmcnt(2)
  v_pk_fma_f32 v[40:41], v[42:43], v[34:35], v[40:41] op_sel_hi:[1,0,1]
  s_waitcnt lgkmcnt(1)
  v_pk_fma_f32 v[40:41], v[44:45], v[36:37], v[40:41] op_sel_hi:[1,0,1]
  s_waitcnt lgkmcnt(0)
  v_pk_fma_f32 v[40:41], v[46:47], v[38:39], v[40:41] op_sel_hi:[1,0,1]
  s_cmp_lg_u32 s26, 0
  v_or_b32 v52, 1, v40
  v_or_b32 v53, 1, v41
  s_cbranch_scc1 L_h1_far
  buffer_store_dwordx2 v[52:53], v25, s[52:55], s28 offen offset:128
L_h1_st:
  s_cmp_lg_u32 s26, 0
  s_cbranch_scc1 L_h1e_far
  s_waitcnt vmcnt(1)
  buffer_load_dwordx4 v[64:67], v26, s[52:55], s30 offen offset:128 nt
  buffer_load_dwordx4 v[68:71], v26, s[52:55], s30 offen offset:640 nt
  buffer_load_dwordx4 v[72:75], v26, s[52:55], s30 offen offset:1152 nt
  buffer_load_dwordx4 v[76:79], v26, s[52:55], s30 offen offset:1664 nt
  s_waitcnt vmcnt(5)
L_h1e_done:
  ds_read_b64_tr_b16 v[192:193], v176 offset:35392
  ds_read_b64_tr_b16 v[194:195], v176 offset:35904
  ds_read_b64_tr_b16 v[208:209], v177 offset:35392
  ds_read_b64_tr_b16 v[210:211], v177 offset:35904
  ds_read_b64_tr_b16 v[224:225], v178 offset:35392
  ds_read_b64_tr_b16 v[226:227], v178 offset:35904
  ds_read_b64_tr_b16 v[240:241], v179 offset:35392
  ds_read_b64_tr_b16 v[242:243], v179 offset:35904
  s_barrier
  s_cmp_lg_u32 s26, 0
  s_cbranch_scc1 L_h1_farp
  s_mov_b32 s58, 400000
  ds_read_b64_tr_b16 v[196:197], v180 offset:35392
  ds_read_b64_tr_b16 v[198:199], v180 offset:35904
  ds_read_b64_tr_b16 v[212:213], v181 offset:35392
  ds_read_b64_tr_b16 v[214:215], v181 offset:35904
  ds_read_b64_tr_b16 v[228:229], v182 offset:35392
  ds_read_b64_tr_b16 v[230:231], v182 offset:35904
  ds_read_b64_tr_b16 v[244:245], v183 offset:35392
  ds_read_b64_tr_b16 v[246:247], v183 offset:35904
  ds_read_b64_tr_b16 v[200:201], v184 offset:35392
  ds_read_b64_tr_b16 v[202:203], v184 offset:35904
  ds_read_b64_tr_b16 v[216:217], v185 offset:35392
  ds_read_b64_tr_b16 v[218:219], v185 offset:35904
  ds_read_b64_tr_b16 v[232:233], v186 offset:35392
  ds_read_b64_tr_b16 v[234:235], v186 offset:35904
  ds_read_b64_tr_b16 v[248:249], v187 offset:35392
  ds_read_b64_tr_b16 v[250:251], v187 offset:35904
  ds_read_b64_tr_b16 v[204:205], v188 offset:35392
  ds_read_b64_tr_b16 v[206:207], v188 offset:35904
  ds_read_b64_tr_b16 v[220:221], v189 offset:35392
  ds_read_b64_tr_b16 v[222:223], v189 offset:35904
  ds_read_b64_tr_b16 v[236:237], v190 offset:35392
  ds_read_b64_tr_b16 v[238:239], v190 offset:35904
  ds_read_b64_tr_b16 v[252:253], v191 offset:35392
  ds_read_b64_tr_b16 v[254:255], v191 offset:35904
L_h1_chk:
  s_waitcnt vmcnt(0)
  v_bitop3_b32 v80, v64, v65, v66 bitop3:0x80
  v_bitop3_b32 v81, v68, v69, v70 bitop3:0x80
  v_bitop3_b32 v82, v72, v73, v74 bitop3:0x80
  v_bitop3_b32 v83, v76, v77, v78 bitop3:0x80
  v_bitop3_b32 v84, v67, v71, v75 bitop3:0x80
  v_bitop3_b32 v85, v80, v81, v82 bitop3:0x80
  v_bitop3_b32 v86, v83, v79, 1 bitop3:0x80
  v_bitop3_b32 v84, v84, v85, v86 bitop3:0x80
  v_cmp_eq_u32 vcc, 0, v84
  s_nop 0
  s_cbranch_vccz L_h1_got
  v_bitop3_b32 v80, v80, v67, 1 bitop3:0x80
  v_bitop3_b32 v81, v81, v71, 1 bitop3:0x80
  v_bitop3_b32 v82, v82, v75, 1 bitop3:0x80
  v_bitop3_b32 v83, v83, v79, 1 bitop3:0x80
  v_cmp_eq_u32 s[72:73], 0, v80
  v_cmp_eq_u32 s[74:75], 0, v81
  v_cmp_eq_u32 s[76:77], 0, v82
  v_cmp_eq_u32 s[78:79], 0, v83
  s_sub_u32 s58, s58, 1
  s_cbranch_scc1 L_h1_got
  s_mov_b64 exec, s[72:73]
  buffer_load_dwordx4 v[64:67], v26, s[52:55], s30 offen offset:128 nt
  s_mov_b64 exec, s[74:75]
  buffer_load_dwordx4 v[68:71], v26, s[52:55], s30 offen offset:640 nt
  s_mov_b64 exec, s[76:77]
  buffer_load_dwordx4 v[72:75], v26, s[52:55], s30 offen offset:1152 nt
  s_mov_b64 exec, s[78:79]
  buffer_load_dwordx4 v[76:79], v26, s[52:55], s30 offen offset:1664 nt
  s_mov_b64 exec, -1
  s_branch L_h1_chk
L_h1_got:
  s_mov_b64 exec, 1
  ds_add_rtn_u32 v54, v9, v11 offset:24
  s_mov_b64 exec, -1
  v_pk_mul_f32 v[84:85], v[64:65], v[56:57] op_sel:[0,0] op_sel_hi:[1,0]
  v_pk_mul_f32 v[86:87], v[66:67], v[56:57] op_sel:[0,0] op_sel_hi:[1,0]
  v_pk_fma_f32 v[84:85], v[68:69], v[56:57], v[84:85] op_sel:[0,1,0] op_sel_hi:[1,1,1]
  v_pk_fma_f32 v[86:87], v[70:71], v[56:57], v[86:87] op_sel:[0,1,0] op_sel_hi:[1,1,1]
  v_pk_fma_f32 v[84:85], v[72:73], v[58:59], v[84:85] op_sel:[0,0,0] op_sel_hi:[1,0,1]
  v_pk_fma_f32 v[86:87], v[74:75], v[58:59], v[86:87] op_sel:[0,0,0] op_sel_hi:[1,0,1]
  v_pk_fma_f32 v[84:85], v[76:77], v[58:59], v[84:85] op_sel:[0,1,0] op_sel_hi:[1,1,1]
  v_pk_fma_f32 v[86:87], v[78:79], v[58:59], v[86:87] op_sel:[0,1,0] op_sel_hi:[1,1,1]
  v_cvt_pk_bf16_f32 v88, v84, v85
  v_cvt_pk_bf16_f32 v89, v86, v87
  v_mov_b32 v96, v88
  v_mov_b32 v97, v89
  v_mov_b32_dpp v98, v88 row_ror:15 row_mask:0xf bank_mask:0xf
  v_mov_b32_dpp v99, v89 row_ror:15 row_mask:0xf bank_mask:0xf
  v_mov_b32_dpp v100, v88 row_ror:14 row_mask:0xf bank_mask:0xf
  v_mov_b32_dpp v101, v89 row_ror:14 row_mask:0xf bank_mask:0xf
  s_waitcnt lgkmcnt(15)
  v_mfma_f32_16x16x32_bf16 v[112:115], v[96:99], v[192:195], 0
  v_mov_b32_dpp v102, v88 row_ror:13 row_mask:0xf bank_mask:0xf
  v_mov_b32_dpp v103, v89 row_ror:13 row_mask:0xf bank_mask:0xf
  v_mfma_f32_16x16x32_bf16 v[116:119], v[96:99], v[208:211], 0
  v_mfma_f32_16x16x32_bf16 v[120:123], v[96:99], v[224:227], 0
  v_mfma_f32_16x16x32_bf16 v[124:127], v[96:99], v[240:243], 0
  v_mov_b32_dpp v104, v88 row_ror:12 row_mask:0xf bank_mask:0xf
  v_mov_b32_dpp v105, v89 row_ror:12 row_mask:0xf bank_mask:0xf
  v_mfma_f32_16x16x32_bf16 v[112:115], v[100:103], v[196:199], v[112:115]
  v_mov_b32_dpp v106, v88 row_ror:11 row_mask:0xf bank_mask:0xf
  v_mov_b32_dpp v107, v89 row_ror:11 row_mask:0xf bank_mask:0xf
  v_mfma_f32_16x16x32_bf16 v[116:119], v[100:103], v[212:215], v[116:119]
  v_mfma_f32_16x16x32_bf16 v[120:123], v[100:103], v[228:231], v[120:123]
  v_mfma_f32_16x16x32_bf16 v[124:127], v[100:103], v[244:247], v[124:127]
  v_mov_b32_dpp v108, v88 row_ror:10 row_mask:0xf bank_mask:0xf
  v_mov_b32_dpp v109, v89 row_ror:10 row_mask:0xf bank_mask:0xf
  s_waitcnt lgkmcnt(9)
  v_mfma_f32_16x16x32_bf16 v[112:115], v[104:107], v[200:203], v[112:115]
  v_mov_b32_dpp v110, v88 row_ror:9 row_mask:0xf bank_mask:0xf
  v_mov_b32_dpp v111, v89 row_ror:9 row_mask:0xf bank_mask:0xf
  v_mfma_f32_16x16x32_bf16 v[116:119], v[104:107], v[216:219], v[116:119]
  v_mfma_f32_16x16x32_bf16 v[120:123], v[104:107], v[232:235], v[120:123]
  v_mfma_f32_16x16x32_bf16 v[124:127], v[104:107], v[248:251], v[124:127]
  s_waitcnt lgkmcnt(1)
  v_mfma_f32_16x16x32_bf16 v[112:115], v[108:111], v[204:207], v[112:115]
  v_mfma_f32_16x16x32_bf16 v[116:119], v[108:111], v[220:223], v[116:119]
  v_mfma_f32_16x16x32_bf16 v[120:123], v[108:111], v[236:239], v[120:123]
  v_mfma_f32_16x16x32_bf16 v[124:127], v[108:111], v[252:255], v[124:127]
  s_waitcnt lgkmcnt(0)
  v_readfirstlane_b32 s59, v54
  s_nop 2
  v_perm_b32 v128, v112, v10, s16
  v_perm_b32 v129, v116, v10, s17
  v_perm_b32 v130, v120, v10, s18
  v_perm_b32 v131, v124, v10, s19
  s_cmp_eq_u32 s59, 3
  s_cbranch_scc1 L_hl_done
  s_mov_b32 s58, 3200000
L_hl:
  ds_read_b32 v4, v9 offset:24
  s_waitcnt lgkmcnt(0)
  v_readfirstlane_b32 s59, v4
  s_sub_u32 s58, s58, 1
  s_cbranch_scc1 L_hl_done
  s_cmp_lt_u32 s59, 4
  s_cbranch_scc1 L_hl
L_hl_done:
  s_mov_b32 exec_lo, 0xffff
  s_mov_b32 exec_hi, 0xffff
  buffer_store_dwordx4 v[128:131], v28, s[52:55], s8 offen sc1
  s_mov_b64 exec, -1
  s_cmp_lg_u32 s3, 0
  s_cbranch_scc1 L_hend
  s_waitcnt vmcnt(0)
  s_mov_b32 s58, 400000
L_h2:
  buffer_load_dwordx4 v[136:139], v19, s[52:55], s9 offen offset:0 sc1
  buffer_load_dwordx4 v[140:143], v19, s[52:55], s9 offen offset:1024 sc1
  s_waitcnt vmcnt(0)
  v_perm_b32 v56, v137, v136, s20
  v_perm_b32 v57, v139, v138, s21
  v_perm_b32 v58, v141, v140, s20
  v_perm_b32 v59, v143, v142, s21
  v_bitop3_b32 v56, v56, v57, s12 bitop3:0x56
  v_bitop3_b32 v58, v58, v59, s12 bitop3:0x56
  v_or_b32 v56, v56, v58
  v_cmp_ne_u32 vcc, 0, v56
  s_nop 0
  s_cbranch_vccz L_h2_done
  s_sub_u32 s58, s58, 1
  s_cbranch_scc1 L_h2_done
  s_and_b64 exec, exec, vcc
  s_branch L_h2
L_h2_done:
  s_mov_b64 exec, -1
  v_and_b32 v48, 0xffffff00, v136
  v_and_b32 v49, 0xffffff00, v137
  v_and_b32 v50, 0xffffff00, v138
  v_and_b32 v51, 0xffffff00, v139
  v_and_b32 v52, 0xffffff00, v140
  v_and_b32 v53, 0xffffff00, v141
  v_and_b32 v54, 0xffffff00, v142
  v_and_b32 v55, 0xffffff00, v143
  v_add_f32 v48, v48, v52
  v_add_f32 v49, v49, v53
  v_add_f32 v50, v50, v54
  v_add_f32 v51, v51, v55
  s_nop 0
  v_permlane32_swap_b32 v48, v50
  v_permlane32_swap_b32 v49, v51
  v_add_f32 v48, v48, v50
  v_add_f32 v49, v49, v51
  s_nop 1
  v_permlane16_swap_b32 v48, v49
  v_add_f32 v48, v48, v49
  s_nop 1
  v_add_f32_dpp v48, v48, v48 row_ror:4 row_mask:0xf bank_mask:0xf
  s_nop 1
  v_add_f32_dpp v48, v48, v48 row_ror:8 row_mask:0xf bank_mask:0xf
  s_mov_b32 exec_lo, 0x000f000f
  s_mov_b32 exec_hi, 0x000f000f
  v_cvt_pk_bf16_f32 v48, 0, v48
  v_mul_f32 v48, v48, v16
  v_cvt_pk_bf16_f32 v48, 0, v48
  v_add_f32 v48, v48, v14
  v_cvt_pk_bf16_f32 v48, v48, v48
  buffer_store_short v48, v30, s[64:67], s10 offen
  s_mov_b64 exec, 1
  s_cmp_lg_u32 s2, 0
  s_cbranch_scc1 L_hend
  v_mov_b32 v60, s42
  buffer_store_dword v60, v9, s[52:55], 0 offen
L_hend:
L_end:
  s_endpgm
L_h1_far:
  buffer_store_dwordx2 v[52:53], v25, s[52:55], s28 offen offset:128 sc1
  s_branch L_h1_st
L_h1e_far:
  s_waitcnt vmcnt(1)
  s_branch L_h1e_done
L_h1_farp:
  s_mov_b32 s58, 400000
  buffer_load_dwordx4 v[64:67], v26, s[52:55], s30 offen offset:128 sc1
  buffer_load_dwordx4 v[68:71], v26, s[52:55], s30 offen offset:640 sc1
  buffer_load_dwordx4 v[72:75], v26, s[52:55], s30 offen offset:1152 sc1
  buffer_load_dwordx4 v[76:79], v26, s[52:55], s30 offen offset:1664 sc1
  ds_read_b64_tr_b16 v[196:197], v180 offset:35392
  ds_read_b64_tr_b16 v[198:199], v180 offset:35904
  ds_read_b64_tr_b16 v[212:213], v181 offset:35392
  ds_read_b64_tr_b16 v[214:215], v181 offset:35904
  ds_read_b64_tr_b16 v[228:229], v182 offset:35392
  ds_read_b64_tr_b16 v[230:231], v182 offset:35904
  ds_read_b64_tr_b16 v[244:245], v183 offset:35392
  ds_read_b64_tr_b16 v[246:247], v183 offset:35904
  ds_read_b64_tr_b16 v[200:201], v184 offset:35392
  ds_read_b64_tr_b16 v[202:203], v184 offset:35904
  ds_read_b64_tr_b16 v[216:217], v185 offset:35392
  ds_read_b64_tr_b16 v[218:219], v185 offset:35904
  ds_read_b64_tr_b16 v[232:233], v186 offset:35392
  ds_read_b64_tr_b16 v[234:235], v186 offset:35904
  ds_read_b64_tr_b16 v[248:249], v187 offset:35392
  ds_read_b64_tr_b16 v[250:251], v187 offset:35904
  ds_read_b64_tr_b16 v[204:205], v188 offset:35392
  ds_read_b64_tr_b16 v[206:207], v188 offset:35904
  ds_read_b64_tr_b16 v[220:221], v189 offset:35392
  ds_read_b64_tr_b16 v[222:223], v189 offset:35904
  ds_read_b64_tr_b16 v[236:237], v190 offset:35392
  ds_read_b64_tr_b16 v[238:239], v190 offset:35904
  ds_read_b64_tr_b16 v[252:253], v191 offset:35392
  ds_read_b64_tr_b16 v[254:255], v191 offset:35904
  s_branch L_h1x_chk
L_h1x:
  buffer_load_dwordx4 v[64:67], v26, s[52:55], s30 offen offset:128 sc1
  buffer_load_dwordx4 v[68:71], v26, s[52:55], s30 offen offset:640 sc1
  buffer_load_dwordx4 v[72:75], v26, s[52:55], s30 offen offset:1152 sc1
  buffer_load_dwordx4 v[76:79], v26, s[52:55], s30 offen offset:1664 sc1
L_h1x_chk:
  s_waitcnt vmcnt(0)
  v_bitop3_b32 v80, v64, v65, v66 bitop3:0x80
  v_bitop3_b32 v81, v68, v69, v70 bitop3:0x80
  v_bitop3_b32 v82, v72, v73, v74 bitop3:0x80
  v_bitop3_b32 v83, v76, v77, v78 bitop3:0x80
  v_bitop3_b32 v84, v67, v71, v75 bitop3:0x80
  v_bitop3_b32 v85, v80, v81, v82 bitop3:0x80
  v_bitop3_b32 v86, v83, v79, 1 bitop3:0x80
  v_bitop3_b32 v84, v84, v85, v86 bitop3:0x80
  v_xor_b32 v84, 1, v84
  v_cmp_ne_u32 vcc, 0, v84
  s_nop 0
  s_cbranch_vccz L_h1x_done
  s_sub_u32 s58, s58, 1
  s_cbranch_scc1 L_h1x_done
  s_and_b64 exec, exec, vcc
  s_branch L_h1x
L_h1x_done:
  s_mov_b64 exec, -1
  s_branch L_h1_got
L_meas:
  s_cmp_lt_u32 s3, 2
  s_cbranch_scc1 L_meas_done
  s_and_b32 s4, s3, 1
  s_lshl_b32 s4, s4, 13
  s_lshl_b32 s5, s2, 7
  s_add_u32 s4, s4, s5
  s_memtime s[76:77]
  s_waitcnt lgkmcnt(0)
  s_load_dword s5, s[40:41], s4 offset:49152
  s_waitcnt lgkmcnt(0)
  s_memtime s[78:79]
  s_lshl_b32 s4, s3, 2
  v_mov_b32 v5, s4
  s_waitcnt lgkmcnt(0)
  s_sub_u32 s78, s78, s76
  v_mov_b32 v6, s78
  ds_write_b32 v5, v6 offset:1464
  s_waitcnt lgkmcnt(0)
  s_branch L_meas_done
L_mpub:
  ds_read_b64 v[94:95], v9 offset:1472
  s_lshl_b32 s4, s2, 3
  s_add_u32 s4, s4, 16384
  s_movk_i32 s5, 600
  s_mov_b64 exec, 1
  s_waitcnt lgkmcnt(0)
  v_sub_u32 v94, v94, v95
  v_min_i32 v94, s5, v94
  v_sub_u32 v95, 0, v94
  v_min_i32 v95, s5, v95
  v_sub_u32 v94, 0, v95
  v_mov_b32 v95, s12
  buffer_store_dwordx2 v[94:95], v9, s[52:55], s4 offen sc1
  s_mov_b64 exec, -1
  s_branch L_mpub_done
L_qs_far:
  buffer_store_dwordx4 v[132:135], v25, s[52:55], s72 offen sc1
  s_branch L_qs_done
L_gq_far:
  s_mov_b32 s58, 400000
L_gqx:
  buffer_load_dwordx4 v[96:99], v2, s[52:55], s6 offen offset:0 sc1
  buffer_load_dwordx4 v[100:103], v2, s[52:55], s6 offen offset:1024 sc1
  s_waitcnt vmcnt(0)
  v_perm_b32 v104, v97, v96, s20
  v_perm_b32 v105, v99, v98, s21
  v_perm_b32 v106, v101, v100, s20
  v_perm_b32 v107, v103, v102, s21
  v_bitop3_b32 v104, v104, v105, s25 bitop3:0x56
  v_bitop3_b32 v106, v106, v107, s25 bitop3:0x56
  v_or_b32 v104, v104, v106
  v_cmp_ne_u32 vcc, 0, v104
  s_nop 0
  s_cbranch_vccz L_gqx_done
  s_sub_u32 s58, s58, 1
  s_cbranch_scc1 L_gqx_done
  s_and_b64 exec, exec, vcc
  s_branch L_gqx
L_gqx_done:
  s_mov_b64 exec, -1
  s_branch L_gq_got
L_cx:
  s_waitcnt lgkmcnt(0)
  s_add_u32 s62, s62, s70
  s_mov_b32 s71, 0
  s_sub_u32 s16, s16, s62
  s_cmp_eq_u32 s17, s73
  s_cselect_b32 s16, s16, 0
  s_add_u32 s71, s71, s16
  s_sub_u32 s18, s18, s62
  s_cmp_eq_u32 s19, s73
  s_cselect_b32 s18, s18, 0
  s_add_u32 s71, s71, s18
  s_sub_u32 s20, s20, s62
  s_cmp_eq_u32 s21, s73
  s_cselect_b32 s20, s20, 0
  s_add_u32 s71, s71, s20
  s_sub_u32 s22, s22, s62
  s_cmp_eq_u32 s23, s73
  s_cselect_b32 s22, s22, 0
  s_add_u32 s71, s71, s22
  s_sub_u32 s24, s24, s62
  s_cmp_eq_u32 s25, s73
  s_cselect_b32 s24, s24, 0
  s_add_u32 s71, s71, s24
  s_sub_u32 s26, s26, s62
  s_cmp_eq_u32 s27, s73
  s_cselect_b32 s26, s26, 0
  s_add_u32 s71, s71, s26
  s_sub_u32 s28, s28, s62
  s_cmp_eq_u32 s29, s73
  s_cselect_b32 s28, s28, 0
  s_add_u32 s71, s71, s28
  s_sub_u32 s30, s30, s62
  s_cmp_eq_u32 s31, s73
  s_cselect_b32 s30, s30, 0
  s_add_u32 s71, s71, s30
  s_ashr_i32 s71, s71, 3
  s_add_u32 s70, s70, s71
  s_setpc_b64 s[80:81]
L_mlp:
  v_mul_f32 v66, s4, v40
  v_mul_f32 v67, s4, v41
  v_mul_f32 v68, s4, v42
  v_mul_f32 v69, s4, v43
  v_mul_f32 v70, s4, v44
  v_mul_f32 v71, s4, v45
  v_mul_f32 v72, s4, v46
  v_cvt_pk_bf16_f32 v66, 0, v66
  v_cvt_pk_bf16_f32 v67, 0, v67
  v_cvt_pk_bf16_f32 v68, 0, v68
  v_cvt_pk_bf16_f32 v69, 0, v69
  v_cvt_pk_bf16_f32 v70, 0, v70
  v_cvt_pk_bf16_f32 v71, 0, v71
  v_cvt_pk_bf16_f32 v72, 0, v72
  v_add_f32 v66, v66, v47
  v_add_f32 v67, v67, v48
  v_add_f32 v68, v68, v49
  v_add_f32 v69, v69, v50
  v_add_f32 v70, v70, v51
  v_add_f32 v71, v71, v52
  v_add_f32 v72, v72, v53
  v_cvt_pk_bf16_f32 v66, 0, v66
  v_cvt_pk_bf16_f32 v67, 0, v67
  v_cvt_pk_bf16_f32 v68, 0, v68
  v_cvt_pk_bf16_f32 v69, 0, v69
  v_cvt_pk_bf16_f32 v70, 0, v70
  v_cvt_pk_bf16_f32 v71, 0, v71
  v_cvt_pk_bf16_f32 v72, 0, v72
  v_mul_f32 v73, v66, v66
  v_mul_f32 v74, v67, v67
  v_mul_f32 v75, v68, v68
  v_mul_f32 v76, v69, v69
  v_mul_f32 v77, v70, v70
  v_mul_f32 v78, v71, v71
  v_mul_f32 v79, v72, v72
  v_fmaak_f32 v73, v73, v88, 0xc0135761
  v_fmaak_f32 v74, v74, v88, 0xc0135761
  v_fmaak_f32 v75, v75, v88, 0xc0135761
  v_fmaak_f32 v76, v76, v88, 0xc0135761
  v_fmaak_f32 v77, v77, v88, 0xc0135761
  v_fmaak_f32 v78, v78, v88, 0xc0135761
  v_fmaak_f32 v79, v79, v88, 0xc0135761
  v_mul_f32 v73, v73, v66
  v_mul_f32 v74, v74, v67
  v_mul_f32 v75, v75, v68
  v_mul_f32 v76, v76, v69
  v_mul_f32 v77, v77, v70
  v_mul_f32 v78, v78, v71
  v_mul_f32 v79, v79, v72
  v_exp_f32 v80, v73
  v_exp_f32 v81, v74
  v_exp_f32 v82, v75
  v_exp_f32 v83, v76
  v_exp_f32 v84, v77
  v_exp_f32 v85, v78
  v_exp_f32 v86, v79
  v_add_f32 v80, 1.0, v80
  v_add_f32 v81, 1.0, v81
  v_add_f32 v82, 1.0, v82
  v_add_f32 v83, 1.0, v83
  v_add_f32 v84, 1.0, v84
  v_add_f32 v85, 1.0, v85
  v_add_f32 v86, 1.0, v86
  v_rcp_f32 v80, v80
  v_rcp_f32 v81, v81
  v_rcp_f32 v82, v82
  v_rcp_f32 v83, v83
  v_rcp_f32 v84, v84
  v_rcp_f32 v85, v85
  v_rcp_f32 v86, v86
  v_mul_f32 v80, v66, v80
  v_mul_f32 v81, v67, v81
  v_mul_f32 v82, v68, v82
  v_mul_f32 v83, v69, v83
  v_mul_f32 v84, v70, v84
  v_mul_f32 v85, v71, v85
  v_mul_f32 v86, v72, v86
  v_cvt_pk_bf16_f32 v80, 0, v80
  v_cvt_pk_bf16_f32 v81, 0, v81
  v_cvt_pk_bf16_f32 v82, 0, v82
  v_cvt_pk_bf16_f32 v83, 0, v83
  v_cvt_pk_bf16_f32 v84, 0, v84
  v_cvt_pk_bf16_f32 v85, 0, v85
  v_cvt_pk_bf16_f32 v86, 0, v86
  v_mul_f32 v87, v54, v80
  v_mul_f32 v73, v55, v81
  v_fmac_f32 v87, v56, v82
  v_fmac_f32 v73, v57, v83
  v_fmac_f32 v87, v58, v84
  v_fmac_f32 v73, v59, v85
  v_fmac_f32 v87, v60, v86
  v_add_f32 v87, v87, v73
  s_nop 1
  v_add_f32_dpp v87, v87, v87 row_ror:8 row_mask:0xf bank_mask:0xf
  s_nop 1
  v_add_f32_dpp v87, v87, v87 row_ror:4 row_mask:0xf bank_mask:0xf
  s_nop 1
  v_add_f32_dpp v87, v87, v87 row_ror:2 row_mask:0xf bank_mask:0xf
  s_nop 1
  v_add_f32_dpp v87, v87, v87 row_ror:1 row_mask:0xf bank_mask:0xf
  v_mov_b32 v73, v87
  s_nop 1
  v_permlane16_swap_b32 v87, v73
  v_add_f32 v87, v87, v73
  v_mov_b32 v73, v87
  s_nop 1
  v_permlane32_swap_b32 v87, v73
  v_add_f32 v87, v87, v73
  s_mov_b64 exec, 1
  ds_write_b32 v89, v87 offset:1216
  s_mov_b64 exec, -1
  v_add_u32 v89, 4, v89
L_last:
  s_setpc_b64 s[80:81]
.section .rodata,"a"
.p2align 6
.amdhsa_kernel recurrent_scan__gqa_block_cached__mixer_token_mlp__decode_kernel
  .amdhsa_next_free_vgpr 256
  .amdhsa_next_free_sgpr 102
  .amdhsa_accum_offset 256
  .amdhsa_group_segment_fixed_size 0
  .amdhsa_kernarg_size 104
  .amdhsa_user_sgpr_count 2
  .amdhsa_user_sgpr_kernarg_segment_ptr 1
  .amdhsa_system_sgpr_workgroup_id_x 1
.end_amdhsa_kernel
```
